```python
import torch

def _softmax(x, axis=-1):
    return torch.softmax(x, dim=axis)
def _gelu(x):
    return torch.nn.functional.gelu(x, approximate="tanh")
def _silu(x):
    return torch.nn.functional.silu(x)
def _sigmoid(x):
    return torch.sigmoid(x)
def _layernorm(x, axis=-1, eps=1e-5):
    m = x.mean(dim=axis, keepdim=True)
    v = x.var(dim=axis, keepdim=True, unbiased=False)
    return (x - m) / torch.sqrt(v + eps)
def _scatter_add(tgt, idx, src, axis=0):
    return tgt.clone().index_add_(axis, idx, src)
def _segment_sum(src, seg, n):
    out = torch.zeros((n,) + src.shape[1:], dtype=src.dtype)
    return out.index_add_(0, seg, src)
def _pad(x, pw):
    flat = tuple(v for pair in reversed(pw) for v in pair)
    return torch.nn.functional.pad(x, flat)

kernel_name = 'interleave_layers__ssm_conv_h3__sliding_block__prompt'

def setup_inputs():

    _w = (lambda a: (lambda t: t.to(torch.bfloat16) if t.is_floating_point() else t)(torch.as_tensor(a)))
    def _A_setup():
        B, S, D = 1, 2048, 448
        ks = 4
        return {
            "q": _w((lambda *s: torch.randn(*s, dtype=torch.bfloat16) * 0.05)(B, S, D)),
            "k": _w((lambda *s: torch.randn(*s, dtype=torch.bfloat16) * 0.4)(B, S, D)),
            "v": _w((lambda *s: torch.randn(*s, dtype=torch.bfloat16) * 0.4)(B, S, D)),
            "shift_k": _w((lambda *s: torch.randn(*s, dtype=torch.bfloat16) * 0.4)(D, ks) * 0.5),
            "ssm_k": _w((lambda *s: torch.randn(*s, dtype=torch.bfloat16) * 0.4)(D, S) * (1.0 / S ** 0.5)),
            "ssm_D": _w((lambda *s: torch.randn(*s, dtype=torch.bfloat16) * 0.4)(D)),
        }
    _A_in = _A_setup()

    def _B_setup():
        B, S, D = 1, 2048, 448
        return {
            "x": _w((lambda *s: torch.randn(*s, dtype=torch.bfloat16) * 0.05)(B, S, D)),
            "wqkv": _w((lambda *s: torch.randn(*s, dtype=torch.bfloat16) * 0.05)(D, 3 * D)),
            "wo": _w((lambda *s: torch.randn(*s, dtype=torch.bfloat16) * 0.05)(D, D)),
        }
    _B_in = _B_setup()

    return {
        "A_q": _A_in["q"],
        "A_k": _A_in["k"],
        "A_v": _A_in["v"],
        "A_shift_k": _A_in["shift_k"],
        "A_ssm_k": _A_in["ssm_k"],
        "A_ssm_D": _A_in["ssm_D"],
        "B_x": _B_in["x"],
        "B_wqkv": _B_in["wqkv"],
        "B_wo": _B_in["wo"],
    }

def reference(A_q, A_k, A_v, A_shift_k, A_ssm_k, A_ssm_D, B_x, B_wqkv, B_wo):
    def _A_ref(q, k, v, shift_k, ssm_k, ssm_D):
        B, S, D = q.shape
        ks = shift_k.shape[-1]
        k_pad = _pad(k, ((0, 0), (ks - 1, 0), (0, 0)))
        k_shift = torch.zeros_like(k)
        for t in range(ks):
            k_shift = k_shift + k_pad[:, t:t + S, :] * shift_k[:, ks - 1 - t][None, None, :]
        kv = k_shift * v
        L = 2 * S
        kv_pad = _pad(kv, ((0, 0), (0, S), (0, 0)))
        kf_pad = _pad(ssm_k, ((0, 0), (0, S)))
        kv_f = (lambda x, axes=(-2,-1): torch.fft.rfft2(x.float(), dim=axes))(kv_pad[:, None, :, :], axes=(1, 2))
        kf_f = (lambda x, axes=(-2,-1): torch.fft.rfft2(x.float(), dim=axes))(kf_pad[:, None, :], axes=(1, 2))
        kf_f = (lambda x, *d: x.permute(*d))(kf_f, 1, 2, 0)
        y_f = kv_f * kf_f[None, :, :, :]
        y = (lambda x, s, axes=(-2,-1): torch.fft.irfft2(x, s=s, dim=axes).to(torch.bfloat16))(y_f, (1, L), axes=(1, 2))[:, 0, :S, :]
        y = y + kv * ssm_D[None, None, :]
        return q * y

    def _B_ref(x, wqkv, wo):
        B, S, D = x.shape
        H = 16; Dh = D // H; W = 256
        qkv = (lambda x, *d: x.permute(*d))((x @ wqkv).reshape(B, S, 3, H, Dh), 2, 0, 3, 1, 4)
        q, k, v = qkv[0], qkv[1], qkv[2]
        scores = torch.einsum("bhqd,bhkd->bhqk", q, k) * (Dh ** -0.5)
        idx = torch.arange(S)
        mask = (idx[:, None] - idx[None, :] >= 0) & (idx[:, None] - idx[None, :] < W)
        scores = torch.where(mask[None, None], scores, -1e9)
        p = _softmax(scores, axis=-1)
        o = torch.einsum("bhqk,bhkd->bhqd", p, v)
        return (lambda x, *d: x.permute(*d))(o, 0, 2, 1, 3).reshape(B, S, D) @ wo

    x = A_q
    x = x + _A_ref(_layernorm(x, axis=-1), A_k, A_v, A_shift_k, A_ssm_k, A_ssm_D)
    x = x + _B_ref(_layernorm(x, axis=-1), B_wqkv, B_wo)
    x = x + _A_ref(_layernorm(x, axis=-1), A_k, A_v, A_shift_k, A_ssm_k, A_ssm_D)
    x = x + _B_ref(_layernorm(x, axis=-1), B_wqkv, B_wo)
    return x
```

```asm
; @launch grid=(256,1,1) block=(512,1,1) lds=163840
.amdgcn_target "amdgcn-amd-amdhsa--gfx950"
.text
.globl interleave_layers__ssm_conv_h3__sliding_block__prompt_kernel
.p2align 8
.type interleave_layers__ssm_conv_h3__sliding_block__prompt_kernel,@function
interleave_layers__ssm_conv_h3__sliding_block__prompt_kernel:
    s_cmp_ge_u32 s2, 256
    s_cbranch_scc1 m_end
    v_lshrrev_b32 v1, 6, v0
    v_and_b32 v2, 63, v0
    v_readfirstlane_b32 s3, v1
    s_load_dwordx16 s[16:31], s[0:1], 0
    s_load_dwordx8 s[32:39], s[0:1], 64
    v_and_b32 v3, 15, v2
    v_lshrrev_b32 v4, 4, v2
    v_lshlrev_b32 v5, 4, v2
    s_and_b32 s10, s2, 7
    s_lshr_b32 s11, s2, 3
    s_lshl_b32 s4, s10, 2
    s_lshr_b32 s12, s11, 3
    s_add_u32 s4, s4, s12
    s_and_b32 s5, s11, 7
    s_lshr_b32 s8, s4, 1
    s_and_b32 s9, s11, 15
    s_lshr_b32 s6, s3, 1
    s_and_b32 s7, s3, 1
    s_mov_b32 s76, 0x3b124925
    s_mov_b32 s77, 0x3727c5ac
    s_mov_b32 s78, 0x3f803f80
    s_mov_b32 s79, 0x3e8b97f6
    s_lshl_b32 s10, s4, 6
    s_lshl_b32 s11, s6, 4
    s_add_u32 s10, s10, s11
    v_add_u32 v6, s10, v3
    s_movk_i32 s11, 896
    v_mul_lo_u32 v6, v6, s11
    s_mul_i32 s10, s7, 448
    v_lshl_add_u32 v6, v4, 4, v6
    v_add_u32 v6, s10, v6
    s_waitcnt lgkmcnt(0)
    s_mov_b32 s60, s38
    s_mov_b32 s61, s39
    s_mov_b32 s62, 268435456
    s_mov_b32 s63, 0x00020000
    v_add_u32 v7, 4096, v5
    s_mov_b32 s75, 0
    s_cmp_lg_u32 s2, 0
    s_cbranch_scc1 m_ntok
    s_cmp_lg_u32 s3, 7
    s_cbranch_scc1 m_ntok
    s_memrealtime s[10:11]
    s_mov_b32 s40, s36
    s_mov_b32 s41, s37
    s_mov_b32 s42, 256
    s_mov_b32 s43, 0x00020000
    s_waitcnt lgkmcnt(0)
    s_or_b32 s10, s10, 1
    s_lshl_b32 s11, s11, 8
    s_or_b32 s11, s11, 0x80000000
    v_mov_b32 v8, s10
    v_mov_b32 v9, s11
    v_mov_b32 v10, 0
    s_mov_b64 exec, 1
    buffer_store_dwordx2 v[8:9], v10, s[40:43], 0 offen sc1
    s_mov_b64 exec, -1
m_ntok:
    s_cmp_ge_u32 s2, 224
    s_cbranch_scc1 m_nop1
    s_lshl_b32 s13, s2, 2
    s_add_u32 s14, s26, s13
    s_addc_u32 s15, s27, 0
    s_load_dword s64, s[14:15], 0
    s_lshr_b32 s10, s2, 5
    s_and_b32 s11, s2, 31
    v_and_b32 v8, 31, v0
    v_lshrrev_b32 v9, 5, v0
    s_lshl_b32 s12, s11, 6
    v_lshl_add_u32 v10, v9, 2, s12
    s_lshl_b32 s13, s10, 7
    v_lshl_add_u32 v11, v8, 2, s13
    s_movk_i32 s14, 896
    v_mad_u32_u24 v12, v10, s14, v11
    v_subrev_u32 v13, 2688, v12
    v_subrev_u32 v14, 1792, v12
    v_subrev_u32 v15, 896, v12
    v_lshlrev_b32 v125, 2, v11
    s_mov_b32 s40, s18
    s_mov_b32 s41, s19
    s_mov_b32 s42, 1835008
    s_mov_b32 s43, 0x00020000
    s_mov_b32 s44, s20
    s_mov_b32 s45, s21
    s_mov_b32 s46, 1835008
    s_mov_b32 s47, 0x00020000
    s_mov_b32 s48, s22
    s_mov_b32 s49, s23
    s_mov_b32 s50, 3584
    s_mov_b32 s51, 0x00020000
    buffer_load_dwordx4 v[28:31], v125, s[48:51], 0 offen
    buffer_load_dword v16, v13, s[40:43], 0 offen
    buffer_load_dword v17, v14, s[40:43], 0 offen
    buffer_load_dword v18, v15, s[40:43], 0 offen
    buffer_load_dword v19, v12, s[40:43], 0 offen offset:0
    buffer_load_dword v20, v12, s[40:43], 0 offen offset:896
    buffer_load_dword v21, v12, s[40:43], 0 offen offset:1792
    buffer_load_dword v22, v12, s[40:43], 0 offen offset:2688
    buffer_load_dword v24, v12, s[44:47], 0 offen offset:0
    buffer_load_dword v25, v12, s[44:47], 0 offen offset:896
    buffer_load_dword v26, v12, s[44:47], 0 offen offset:1792
    buffer_load_dword v27, v12, s[44:47], 0 offen offset:2688
    v_mul_u32_u24 v126, 288, v8
    v_sub_u32 v127, 15, v9
    v_lshl_add_u32 v126, v127, 3, v126
    v_add_u32 v126, 70000, v126
    v_lshrrev_b32 v127, 3, v0
    v_and_b32 v129, 7, v0
    v_mul_u32_u24 v130, 144, v127
    v_lshl_add_u32 v130, v129, 4, v130
    v_add_u32 v130, 70000, v130
    s_movk_i32 s14, 4224
    v_mul_lo_u32 v131, v127, s14
    v_lshl_add_u32 v131, v129, 4, v131
    s_mul_i32 s14, s10, 270336
    s_lshl_b32 s15, s11, 7
    s_sub_u32 s14, s14, s15
    s_add_u32 s70, s14, 3968
    s_waitcnt vmcnt(11)
    v_lshlrev_b32 v48, 16, v28
    v_and_b32 v49, 0xffff0000, v28
    v_lshlrev_b32 v50, 16, v29
    v_and_b32 v51, 0xffff0000, v29
    v_lshlrev_b32 v52, 16, v30
    v_and_b32 v53, 0xffff0000, v30
    v_lshlrev_b32 v54, 16, v31
    v_and_b32 v55, 0xffff0000, v31
    s_waitcnt vmcnt(4)
    v_lshlrev_b32 v32, 16, v16
    v_and_b32 v39, 0xffff0000, v16
    v_lshlrev_b32 v33, 16, v17
    v_and_b32 v40, 0xffff0000, v17
    v_lshlrev_b32 v34, 16, v18
    v_and_b32 v41, 0xffff0000, v18
    v_lshlrev_b32 v35, 16, v19
    v_and_b32 v42, 0xffff0000, v19
    v_lshlrev_b32 v36, 16, v20
    v_and_b32 v43, 0xffff0000, v20
    v_lshlrev_b32 v37, 16, v21
    v_and_b32 v44, 0xffff0000, v21
    v_lshlrev_b32 v38, 16, v22
    v_and_b32 v45, 0xffff0000, v22
    v_mul_f32 v64, v32, v51
    v_mul_f32 v68, v39, v55
    v_mul_f32 v65, v33, v51
    v_mul_f32 v69, v40, v55
    v_mul_f32 v66, v34, v51
    v_mul_f32 v70, v41, v55
    v_mul_f32 v67, v35, v51
    v_mul_f32 v71, v42, v55
    v_cvt_pk_bf16_f32 v16, v64, v68
    v_cvt_pk_bf16_f32 v17, v65, v69
    v_cvt_pk_bf16_f32 v18, v66, v70
    v_cvt_pk_bf16_f32 v19, v67, v71
    v_lshlrev_b32 v64, 16, v16
    v_and_b32 v68, 0xffff0000, v16
    v_lshlrev_b32 v65, 16, v17
    v_and_b32 v69, 0xffff0000, v17
    v_lshlrev_b32 v66, 16, v18
    v_and_b32 v70, 0xffff0000, v18
    v_lshlrev_b32 v67, 16, v19
    v_and_b32 v71, 0xffff0000, v19
    v_mul_f32 v72, v33, v50
    v_mul_f32 v73, v40, v54
    v_mul_f32 v74, v34, v50
    v_mul_f32 v75, v41, v54
    v_mul_f32 v76, v35, v50
    v_mul_f32 v77, v42, v54
    v_mul_f32 v78, v36, v50
    v_mul_f32 v79, v43, v54
    v_cvt_pk_bf16_f32 v16, v72, v73
    v_cvt_pk_bf16_f32 v17, v74, v75
    v_cvt_pk_bf16_f32 v18, v76, v77
    v_cvt_pk_bf16_f32 v19, v78, v79
    v_lshlrev_b32 v72, 16, v16
    v_and_b32 v73, 0xffff0000, v16
    v_lshlrev_b32 v74, 16, v17
    v_and_b32 v75, 0xffff0000, v17
    v_lshlrev_b32 v76, 16, v18
    v_and_b32 v77, 0xffff0000, v18
    v_lshlrev_b32 v78, 16, v19
    v_and_b32 v79, 0xffff0000, v19
    v_add_f32 v64, v64, v72
    v_add_f32 v68, v68, v73
    v_add_f32 v65, v65, v74
    v_add_f32 v69, v69, v75
    v_add_f32 v66, v66, v76
    v_add_f32 v70, v70, v77
    v_add_f32 v67, v67, v78
    v_add_f32 v71, v71, v79
    v_cvt_pk_bf16_f32 v16, v64, v68
    v_cvt_pk_bf16_f32 v17, v65, v69
    v_cvt_pk_bf16_f32 v18, v66, v70
    v_cvt_pk_bf16_f32 v19, v67, v71
    v_lshlrev_b32 v64, 16, v16
    v_and_b32 v68, 0xffff0000, v16
    v_lshlrev_b32 v65, 16, v17
    v_and_b32 v69, 0xffff0000, v17
    v_lshlrev_b32 v66, 16, v18
    v_and_b32 v70, 0xffff0000, v18
    v_lshlrev_b32 v67, 16, v19
    v_and_b32 v71, 0xffff0000, v19
    v_mul_f32 v72, v34, v49
    v_mul_f32 v73, v41, v53
    v_mul_f32 v74, v35, v49
    v_mul_f32 v75, v42, v53
    v_mul_f32 v76, v36, v49
    v_mul_f32 v77, v43, v53
    v_mul_f32 v78, v37, v49
    v_mul_f32 v79, v44, v53
    v_cvt_pk_bf16_f32 v16, v72, v73
    v_cvt_pk_bf16_f32 v17, v74, v75
    v_cvt_pk_bf16_f32 v18, v76, v77
    v_cvt_pk_bf16_f32 v19, v78, v79
    v_lshlrev_b32 v72, 16, v16
    v_and_b32 v73, 0xffff0000, v16
    v_lshlrev_b32 v74, 16, v17
    v_and_b32 v75, 0xffff0000, v17
    v_lshlrev_b32 v76, 16, v18
    v_and_b32 v77, 0xffff0000, v18
    v_lshlrev_b32 v78, 16, v19
    v_and_b32 v79, 0xffff0000, v19
    v_add_f32 v64, v64, v72
    v_add_f32 v68, v68, v73
    v_add_f32 v65, v65, v74
    v_add_f32 v69, v69, v75
    v_add_f32 v66, v66, v76
    v_add_f32 v70, v70, v77
    v_add_f32 v67, v67, v78
    v_add_f32 v71, v71, v79
    v_cvt_pk_bf16_f32 v16, v64, v68
    v_cvt_pk_bf16_f32 v17, v65, v69
    v_cvt_pk_bf16_f32 v18, v66, v70
    v_cvt_pk_bf16_f32 v19, v67, v71
    v_lshlrev_b32 v64, 16, v16
    v_and_b32 v68, 0xffff0000, v16
    v_lshlrev_b32 v65, 16, v17
    v_and_b32 v69, 0xffff0000, v17
    v_lshlrev_b32 v66, 16, v18
    v_and_b32 v70, 0xffff0000, v18
    v_lshlrev_b32 v67, 16, v19
    v_and_b32 v71, 0xffff0000, v19
    v_mul_f32 v72, v35, v48
    v_mul_f32 v73, v42, v52
    v_mul_f32 v74, v36, v48
    v_mul_f32 v75, v43, v52
    v_mul_f32 v76, v37, v48
    v_mul_f32 v77, v44, v52
    v_mul_f32 v78, v38, v48
    v_mul_f32 v79, v45, v52
    v_cvt_pk_bf16_f32 v16, v72, v73
    v_cvt_pk_bf16_f32 v17, v74, v75
    v_cvt_pk_bf16_f32 v18, v76, v77
    v_cvt_pk_bf16_f32 v19, v78, v79
    v_lshlrev_b32 v72, 16, v16
    v_and_b32 v73, 0xffff0000, v16
    v_lshlrev_b32 v74, 16, v17
    v_and_b32 v75, 0xffff0000, v17
    v_lshlrev_b32 v76, 16, v18
    v_and_b32 v77, 0xffff0000, v18
    v_lshlrev_b32 v78, 16, v19
    v_and_b32 v79, 0xffff0000, v19
    v_add_f32 v64, v64, v72
    v_add_f32 v68, v68, v73
    v_add_f32 v65, v65, v74
    v_add_f32 v69, v69, v75
    v_add_f32 v66, v66, v76
    v_add_f32 v70, v70, v77
    v_add_f32 v67, v67, v78
    v_add_f32 v71, v71, v79
    v_cvt_pk_bf16_f32 v16, v64, v68
    v_cvt_pk_bf16_f32 v17, v65, v69
    v_cvt_pk_bf16_f32 v18, v66, v70
    v_cvt_pk_bf16_f32 v19, v67, v71
    v_lshlrev_b32 v64, 16, v16
    v_and_b32 v68, 0xffff0000, v16
    v_lshlrev_b32 v65, 16, v17
    v_and_b32 v69, 0xffff0000, v17
    v_lshlrev_b32 v66, 16, v18
    v_and_b32 v70, 0xffff0000, v18
    v_lshlrev_b32 v67, 16, v19
    v_and_b32 v71, 0xffff0000, v19
    s_waitcnt vmcnt(0)
    s_cmp_lg_u32 s3, 0
    s_cbranch_scc1 m_ti1
    s_mov_b32 s40, s36
    s_mov_b32 s41, s37
    s_mov_b32 s42, 256
    s_mov_b32 s43, 0x00020000
    v_mov_b32 v8, 0
    buffer_load_dwordx2 v[10:11], v8, s[40:43], 0 offen sc1
    s_nop 0
m_ti1:
    v_lshlrev_b32 v56, 16, v24
    v_and_b32 v60, 0xffff0000, v24
    v_lshlrev_b32 v57, 16, v25
    v_and_b32 v61, 0xffff0000, v25
    v_lshlrev_b32 v58, 16, v26
    v_and_b32 v62, 0xffff0000, v26
    v_lshlrev_b32 v59, 16, v27
    v_and_b32 v63, 0xffff0000, v27
    v_mul_f32 v64, v64, v56
    v_mul_f32 v68, v68, v60
    v_mul_f32 v65, v65, v57
    v_mul_f32 v69, v69, v61
    v_mul_f32 v66, v66, v58
    v_mul_f32 v70, v70, v62
    v_mul_f32 v67, v67, v59
    v_mul_f32 v71, v71, v63
    v_cvt_pk_bf16_f32 v16, v67, v66
    v_cvt_pk_bf16_f32 v17, v65, v64
    v_cvt_pk_bf16_f32 v18, v71, v70
    v_cvt_pk_bf16_f32 v19, v69, v68
    ds_write_b64 v126, v[16:17] offset:0
    ds_write_b64 v126, v[18:19] offset:144
    s_waitcnt lgkmcnt(0)
    s_barrier
    ds_read_b128 v[20:23], v130
    s_waitcnt lgkmcnt(0)
    buffer_store_dwordx4 v[20:23], v131, s[60:63], s70 offen sc1
    s_lshr_b32 s12, s3, 2
    s_lshl_b32 s13, s2, 1
    s_add_u32 s13, s13, s12
    s_lshl_b32 s13, s13, 12
    s_add_u32 s44, s24, s13
    s_addc_u32 s45, s25, 0
    s_mov_b32 s46, 4096
    s_mov_b32 s47, 0x00020000
    v_and_b32 v128, 255, v0
    v_lshlrev_b32 v128, 4, v128
    v_subrev_u32 v13, 64, v128
    v_subrev_u32 v14, 48, v128
    buffer_load_dwordx4 v[96:99], v13, s[44:47], 0 offen
    buffer_load_dwordx4 v[100:103], v14, s[44:47], 0 offen
    v_add_u32 v13, 4096, v13
    v_add_u32 v14, 4096, v14
    buffer_load_dwordx4 v[104:107], v13, s[44:47], 0 offen
    buffer_load_dwordx4 v[108:111], v14, s[44:47], 0 offen
    s_waitcnt vmcnt(4) lgkmcnt(0)
    s_cmp_lg_u32 s3, 0
    s_cbranch_scc1 m_tk2
    s_mov_b32 s40, s36
    s_mov_b32 s41, s37
    s_mov_b32 s42, 256
    s_mov_b32 s43, 0x00020000
    v_mov_b32 v8, 0
    s_mov_b32 s11, 0
    s_nop 0
    s_branch m_tc2
m_tl2:
    buffer_load_dwordx2 v[10:11], v8, s[40:43], 0 offen sc1
    s_waitcnt vmcnt(0)
m_tc2:
    v_readfirstlane_b32 s56, v10
    v_readfirstlane_b32 s57, v11
    s_add_u32 s11, s11, 1
    s_cmp_gt_u32 s11, 400000
    s_nop 2
    s_cbranch_scc1 m_td2
    s_cmp_eq_u32 s56, 0
    s_cbranch_scc1 m_tl2
    s_cmp_eq_u32 s57, 0
    s_cbranch_scc1 m_tl2
m_td2:
    s_getreg_b32 s10, hwreg(HW_REG_XCC_ID, 0, 4)
    s_or_b32 s57, s57, s10
m_tk2:
    s_barrier
    s_cmp_lg_u32 s3, 0
    s_cbranch_scc1 m_sig3
    s_lshl_b32 s10, s2, 7
    s_add_u32 s10, s10, 9437184
    v_mov_b32 v10, 0
    v_mov_b32 v8, s56
    v_mov_b32 v9, s57
    s_mov_b64 exec, 1
    buffer_store_dwordx2 v[8:9], v10, s[60:63], s10 offen sc1
    s_mov_b64 exec, -1
m_sig3:
    s_cmp_eq_u32 s3, 0
    s_cbranch_scc1 m_nx0
    s_mov_b32 s52, s16
    s_mov_b32 s53, s17
    s_mov_b32 s54, 1835008
    s_mov_b32 s55, 0x00020000
    s_mul_i32 s10, s4, 57344
    s_mul_i32 s11, s3, 7168
    s_add_u32 s10, s10, s11
    s_mul_i32 s11, s6, 14336
    s_add_u32 s11, s11, 101376
    s_cmp_eq_u32 s6, 0
    s_cselect_b32 s11, 51840, s11
    s_mul_i32 s12, s7, 7168
    s_add_u32 s11, s11, s12
    s_mov_b32 m0, s11
    s_nop 0
    buffer_load_dwordx4 v5, s[52:55], s10 offen offset:0 lds
    buffer_load_dwordx4 v5, s[52:55], s10 offen offset:1024 lds
    buffer_load_dwordx4 v5, s[52:55], s10 offen offset:2048 lds
    buffer_load_dwordx4 v5, s[52:55], s10 offen offset:3072 lds
    s_add_u32 s10, s10, 4096
    s_add_u32 s11, s11, 4096
    s_mov_b32 m0, s11
    s_nop 0
    buffer_load_dwordx4 v5, s[52:55], s10 offen offset:0 lds
    buffer_load_dwordx4 v5, s[52:55], s10 offen offset:1024 lds
    buffer_load_dwordx4 v5, s[52:55], s10 offen offset:2048 lds
    s_waitcnt vmcnt(7)
    s_branch m_nx0b
m_nx0:
    s_waitcnt vmcnt(0)
m_nx0b:
    v_mov_b32 v44, 0
    v_mov_b32 v45, 0
    v_mov_b32 v46, 0
    v_mov_b32 v47, 0
    s_lshr_b32 s10, s3, 2
    s_mul_i32 s10, s10, 25920
    s_bfe_u32 s11, s3, 0x10001
    s_mul_i32 s11, s11, 4640
    s_add_u32 s11, s11, s10
    v_add_u32 v9, s11, v5
    v_cmp_gt_u32 vcc, 28, v2
    s_nop 1
    s_and_saveexec_b64 s[72:73], vcc
    ds_write_b128 v9, v[44:47] offset:20736
    s_mov_b64 exec, s[72:73]
    v_add_u32 v8, s10, v128
    v_alignbit_b32 v32, v99, v98, 16
    v_alignbit_b32 v33, v100, v99, 16
    v_alignbit_b32 v34, v101, v100, 16
    v_alignbit_b32 v35, v102, v101, 16
    v_mov_b32 v36, v33
    v_mov_b32 v37, v34
    v_mov_b32 v38, v35
    v_alignbit_b32 v39, v103, v102, 16
    v_mov_b32 v40, v99
    v_mov_b32 v41, v100
    v_mov_b32 v42, v101
    v_mov_b32 v43, v102
    ds_write_b128 v8, v[32:35] offset:0
    ds_write_b128 v8, v[40:43] offset:4160
    ds_write_b128 v8, v[36:39] offset:8320
    ds_write_b128 v8, v[100:103] offset:12480
    v_cmp_gt_u32 vcc, 48, v128
    s_nop 1
    s_and_saveexec_b64 s[72:73], vcc
    v_alignbit_b32 v32, v107, v106, 16
    v_alignbit_b32 v33, v108, v107, 16
    v_alignbit_b32 v34, v109, v108, 16
    v_alignbit_b32 v35, v110, v109, 16
    v_mov_b32 v36, v33
    v_mov_b32 v37, v34
    v_mov_b32 v38, v35
    v_alignbit_b32 v39, v111, v110, 16
    v_mov_b32 v40, v107
    v_mov_b32 v41, v108
    v_mov_b32 v42, v109
    v_mov_b32 v43, v110
    ds_write_b128 v8, v[32:35] offset:4096
    ds_write_b128 v8, v[40:43] offset:8256
    ds_write_b128 v8, v[36:39] offset:12416
    ds_write_b128 v8, v[108:111] offset:16576
    s_mov_b64 exec, s[72:73]
    s_and_b32 s10, s6, 1
    s_lshl_b32 s11, s2, 1
    s_add_u32 s11, s11, s10
    s_mul_i32 s12, s11, 4224
    s_add_u32 s40, s38, s12
    s_addc_u32 s41, s39, 0
    s_mov_b32 s42, 4096
    s_mov_b32 s43, 0x00020000
    s_xor_b32 s14, s7, 1
    s_lshl_b32 s70, s14, 3
    s_mul_i32 s65, s10, 25920
    s_mul_i32 s66, s7, 4640
    s_add_u32 s66, s66, s65
    s_add_u32 s71, s66, 16640
    s_mul_i32 s65, s7, 25920
    v_and_b32 v12, 3, v3
    s_movk_i32 s66, 4160
    v_mul_lo_u32 v12, v12, s66
    v_lshrrev_b32 v13, 2, v3
    v_add_u32 v13, v13, v4
    v_lshl_add_u32 v12, v13, 4, v12
    s_lshl_b32 s67, s6, 7
    s_add_u32 s67, s67, s65
    v_add_u32 v12, s67, v12
    v_and_b32 v13, 1, v3
    s_movk_i32 s66, 4640
    v_mul_lo_u32 v13, v13, s66
    v_lshrrev_b32 v14, 1, v3
    v_lshlrev_b32 v14, 6, v14
    v_sub_u32 v13, v13, v14
    v_lshl_add_u32 v13, v4, 4, v13
    s_add_u32 s67, s67, 17088
    v_add_u32 v13, s67, v13
    s_cmp_lg_u32 s3, 0
    s_nop 0
    s_cbranch_scc1 m_wd4
    s_and_b32 s10, s2, 0xe0
    v_add_u32 v8, 0, v2
    v_min_u32 v8, 31, v8
    v_add_u32 v8, s10, v8
    v_max_i32 v8, 0, v8
    v_lshlrev_b32 v8, 7, v8
    s_mov_b32 s10, 9437184
    s_mov_b32 s11, 0
    buffer_load_dwordx2 v[96:97], v8, s[60:63], s10 offen sc1
    s_sleep 2
m_wl4:
    buffer_load_dwordx2 v[100:101], v8, s[60:63], s10 offen sc1
    s_waitcnt vmcnt(1)
    v_xor_b32 v96, s56, v96
    v_xor_b32 v97, s57, v97
    v_lshrrev_b32 v98, 8, v97
    v_or_b32 v98, v98, v96
    v_cmp_ne_u32 vcc, 0, v98
    s_nop 4
    s_cbranch_vccz m_wa4
    buffer_load_dwordx2 v[96:97], v8, s[60:63], s10 offen sc1
    s_waitcnt vmcnt(1)
    v_xor_b32 v100, s56, v100
    v_xor_b32 v101, s57, v101
    v_lshrrev_b32 v102, 8, v101
    v_or_b32 v102, v102, v100
    v_cmp_ne_u32 vcc, 0, v102
    s_nop 4
    s_cbranch_vccz m_wb4
    s_add_u32 s11, s11, 1
    s_cmp_gt_u32 s11, 200000
    s_cbranch_scc0 m_wl4
    s_branch m_wb4
m_wa4:
m_wb4:
m_wd4:
    s_barrier
    s_cmp_ge_u32 s3, 4
    s_cbranch_scc1 m_nou
    s_mov_b32 m0, s71
    s_nop 0
    buffer_load_dwordx4 v5, s[40:43], s70 offen offset:0 sc1 lds
    buffer_load_dwordx4 v5, s[40:43], s70 offen offset:1024 sc1 lds
    buffer_load_dwordx4 v5, s[40:43], s70 offen offset:2048 sc1 lds
    buffer_load_dwordx4 v5, s[40:43], s70 offen offset:3072 sc1 lds
m_nou:
    s_cmp_lg_u32 s3, 0
    s_cbranch_scc1 m_nx1
    s_mov_b32 s52, s16
    s_mov_b32 s53, s17
    s_mov_b32 s54, 1835008
    s_mov_b32 s55, 0x00020000
    s_mul_i32 s10, s4, 57344
    s_mul_i32 s11, s3, 7168
    s_add_u32 s10, s10, s11
    s_mul_i32 s11, s6, 14336
    s_add_u32 s11, s11, 101376
    s_cmp_eq_u32 s6, 0
    s_cselect_b32 s11, 51840, s11
    s_mul_i32 s12, s7, 7168
    s_add_u32 s11, s11, s12
    s_mov_b32 m0, s11
    s_nop 0
    buffer_load_dwordx4 v5, s[52:55], s10 offen offset:0 lds
    buffer_load_dwordx4 v5, s[52:55], s10 offen offset:1024 lds
    buffer_load_dwordx4 v5, s[52:55], s10 offen offset:2048 lds
    buffer_load_dwordx4 v5, s[52:55], s10 offen offset:3072 lds
    s_add_u32 s10, s10, 4096
    s_add_u32 s11, s11, 4096
    s_mov_b32 m0, s11
    s_nop 0
    buffer_load_dwordx4 v5, s[52:55], s10 offen offset:0 lds
    buffer_load_dwordx4 v5, s[52:55], s10 offen offset:1024 lds
    buffer_load_dwordx4 v5, s[52:55], s10 offen offset:2048 lds
    s_waitcnt vmcnt(7) lgkmcnt(0)
    s_branch m_nx2
m_nx1:
    s_waitcnt vmcnt(0) lgkmcnt(0)
m_nx2:
    s_barrier
    s_mul_i32 s71, s7, 7168
    s_lshl_b32 s72, s5, 2
    s_add_u32 s72, s72, s6
    s_mul_i32 s70, s72, 24576
    s_add_u32 s70, s70, 8388608
    s_mul_i32 s72, s72, 43008
    s_add_u32 s72, s72, s71
    s_add_u32 s72, s72, 6291456
    s_add_u32 s73, s72, 14336
    s_add_u32 s74, s72, 28672
    ds_read_b128 v[48:51], v12
    ds_read_b128 v[80:83], v13 offset:3584
    ds_read_b128 v[84:87], v13 offset:3072
    ds_read_b128 v[88:91], v13 offset:2560
    ds_read_b128 v[92:95], v13 offset:2048
    ds_read_b128 v[96:99], v13 offset:1536
    ds_read_b128 v[100:103], v13 offset:1024
    ds_read_b128 v[104:107], v13 offset:512
    ds_read_b128 v[108:111], v13 offset:0
    ds_read_b128 v[52:55], v12 offset:512
    ds_read_b128 v[56:59], v12 offset:1024
    ds_read_b128 v[60:63], v12 offset:1536
    ds_read_b128 v[64:67], v12 offset:2048
    ds_read_b128 v[68:71], v12 offset:2560
    ds_read_b128 v[72:75], v12 offset:3072
    ds_read_b128 v[76:79], v12 offset:3584
    s_waitcnt lgkmcnt(14)
    v_mfma_f32_16x16x32_bf16 v[16:19], v[48:51], v[80:83], 0
    s_waitcnt lgkmcnt(13)
    v_mfma_f32_16x16x32_bf16 v[20:23], v[48:51], v[84:87], 0
    s_waitcnt lgkmcnt(12)
    v_mfma_f32_16x16x32_bf16 v[24:27], v[48:51], v[88:91], 0
    s_waitcnt lgkmcnt(11)
    v_mfma_f32_16x16x32_bf16 v[28:31], v[48:51], v[92:95], 0
    s_waitcnt lgkmcnt(10)
    v_mfma_f32_16x16x32_bf16 v[32:35], v[48:51], v[96:99], 0
    s_waitcnt lgkmcnt(9)
    v_mfma_f32_16x16x32_bf16 v[36:39], v[48:51], v[100:103], 0
    s_waitcnt lgkmcnt(8)
    v_mfma_f32_16x16x32_bf16 v[40:43], v[48:51], v[104:107], 0
    s_waitcnt lgkmcnt(7)
    v_mfma_f32_16x16x32_bf16 v[44:47], v[48:51], v[108:111], 0
    ds_read_b128 v[48:51], v12 offset:64
    ds_read_b128 v[108:111], v13 offset:64
    s_waitcnt lgkmcnt(8)
    v_mfma_f32_16x16x32_bf16 v[20:23], v[52:55], v[80:83], v[20:23]
    v_mfma_f32_16x16x32_bf16 v[24:27], v[52:55], v[84:87], v[24:27]
    v_mfma_f32_16x16x32_bf16 v[28:31], v[52:55], v[88:91], v[28:31]
    v_mfma_f32_16x16x32_bf16 v[32:35], v[52:55], v[92:95], v[32:35]
    v_mfma_f32_16x16x32_bf16 v[36:39], v[52:55], v[96:99], v[36:39]
    v_mfma_f32_16x16x32_bf16 v[40:43], v[52:55], v[100:103], v[40:43]
    v_mfma_f32_16x16x32_bf16 v[44:47], v[52:55], v[104:107], v[44:47]
    ds_read_b128 v[52:55], v12 offset:576
    ds_read_b128 v[104:107], v13 offset:576
    s_waitcnt lgkmcnt(9)
    v_mfma_f32_16x16x32_bf16 v[24:27], v[56:59], v[80:83], v[24:27]
    v_mfma_f32_16x16x32_bf16 v[28:31], v[56:59], v[84:87], v[28:31]
    v_mfma_f32_16x16x32_bf16 v[32:35], v[56:59], v[88:91], v[32:35]
    v_mfma_f32_16x16x32_bf16 v[36:39], v[56:59], v[92:95], v[36:39]
    v_mfma_f32_16x16x32_bf16 v[40:43], v[56:59], v[96:99], v[40:43]
    v_mfma_f32_16x16x32_bf16 v[44:47], v[56:59], v[100:103], v[44:47]
    ds_read_b128 v[56:59], v12 offset:1088
    ds_read_b128 v[100:103], v13 offset:1088
    s_waitcnt lgkmcnt(10)
    v_mfma_f32_16x16x32_bf16 v[28:31], v[60:63], v[80:83], v[28:31]
    v_mfma_f32_16x16x32_bf16 v[32:35], v[60:63], v[84:87], v[32:35]
    v_mfma_f32_16x16x32_bf16 v[36:39], v[60:63], v[88:91], v[36:39]
    v_mfma_f32_16x16x32_bf16 v[40:43], v[60:63], v[92:95], v[40:43]
    v_mfma_f32_16x16x32_bf16 v[44:47], v[60:63], v[96:99], v[44:47]
    ds_read_b128 v[60:63], v12 offset:1600
    ds_read_b128 v[96:99], v13 offset:1600
    s_waitcnt lgkmcnt(11)
    v_mfma_f32_16x16x32_bf16 v[32:35], v[64:67], v[80:83], v[32:35]
    v_mfma_f32_16x16x32_bf16 v[36:39], v[64:67], v[84:87], v[36:39]
    v_mfma_f32_16x16x32_bf16 v[40:43], v[64:67], v[88:91], v[40:43]
    v_mfma_f32_16x16x32_bf16 v[44:47], v[64:67], v[92:95], v[44:47]
    ds_read_b128 v[64:67], v12 offset:2112
    ds_read_b128 v[92:95], v13 offset:2112
    s_waitcnt lgkmcnt(12)
    v_mfma_f32_16x16x32_bf16 v[36:39], v[68:71], v[80:83], v[36:39]
    v_mfma_f32_16x16x32_bf16 v[40:43], v[68:71], v[84:87], v[40:43]
    v_mfma_f32_16x16x32_bf16 v[44:47], v[68:71], v[88:91], v[44:47]
    ds_read_b128 v[68:71], v12 offset:2624
    ds_read_b128 v[88:91], v13 offset:2624
    s_waitcnt lgkmcnt(13)
    v_mfma_f32_16x16x32_bf16 v[40:43], v[72:75], v[80:83], v[40:43]
    v_mfma_f32_16x16x32_bf16 v[44:47], v[72:75], v[84:87], v[44:47]
    ds_read_b128 v[72:75], v12 offset:3136
    ds_read_b128 v[84:87], v13 offset:3136
    s_waitcnt lgkmcnt(14)
    v_mfma_f32_16x16x32_bf16 v[44:47], v[76:79], v[80:83], v[44:47]
    ds_read_b128 v[76:79], v12 offset:3648
    ds_read_b128 v[80:83], v13 offset:3648
    s_waitcnt lgkmcnt(14)
    v_mfma_f32_16x16x32_bf16 v[44:47], v[48:51], v[108:111], v[44:47]
    s_waitcnt lgkmcnt(12)
    v_mfma_f32_16x16x32_bf16 v[40:43], v[48:51], v[104:107], v[40:43]
    v_mfma_f32_16x16x32_bf16 v[44:47], v[52:55], v[104:107], v[44:47]
    s_waitcnt lgkmcnt(10)
    v_mfma_f32_16x16x32_bf16 v[36:39], v[48:51], v[100:103], v[36:39]
    v_mfma_f32_16x16x32_bf16 v[40:43], v[52:55], v[100:103], v[40:43]
    v_mfma_f32_16x16x32_bf16 v[44:47], v[56:59], v[100:103], v[44:47]
    s_waitcnt lgkmcnt(8)
    v_mfma_f32_16x16x32_bf16 v[32:35], v[48:51], v[96:99], v[32:35]
    v_mfma_f32_16x16x32_bf16 v[36:39], v[52:55], v[96:99], v[36:39]
    v_mfma_f32_16x16x32_bf16 v[40:43], v[56:59], v[96:99], v[40:43]
    v_mfma_f32_16x16x32_bf16 v[44:47], v[60:63], v[96:99], v[44:47]
    s_mul_i32 s66, s7, 6144
    s_add_u32 s66, s66, 66560
    v_add_u32 v112, s66, v5
    v_lshrrev_b32 v113, 1, v3
    v_lshlrev_b32 v113, 5, v113
    v_lshl_add_u32 v113, v4, 3, v113
    v_and_b32 v114, 1, v3
    v_lshl_add_u32 v113, v114, 2, v113
    v_lshlrev_b32 v113, 1, v113
    s_add_u32 s66, s65, 21784
    v_sub_u32 v114, s66, v113
    s_mul_i32 s66, s7, 4224
    v_add_u32 v113, s66, v113
    s_mul_i32 s67, s2, 8448
    s_add_u32 s67, s67, 4194304
    s_lshl_b32 s68, s64, 16
    s_and_b32 s69, s64, 0xffff0000
    s_cmp_eq_u32 s7, 0
    s_cselect_b32 s68, s68, s69
    s_waitcnt lgkmcnt(0)
    s_cmp_eq_u32 s6, 1
    s_cbranch_scc1 m_p1r1
    s_cmp_eq_u32 s6, 2
    s_cbranch_scc1 m_p1r2
    s_cmp_eq_u32 s6, 3
    s_cbranch_scc1 m_p1r3
    v_mfma_f32_16x16x32_bf16 v[44:47], v[64:67], v[92:95], v[44:47]
    v_mfma_f32_16x16x32_bf16 v[44:47], v[68:71], v[88:91], v[44:47]
    v_mfma_f32_16x16x32_bf16 v[44:47], v[72:75], v[84:87], v[44:47]
    v_mfma_f32_16x16x32_bf16 v[44:47], v[76:79], v[80:83], v[44:47]
    v_mfma_f32_16x16x32_bf16 v[40:43], v[60:63], v[92:95], v[40:43]
    v_mfma_f32_16x16x32_bf16 v[40:43], v[64:67], v[88:91], v[40:43]
    v_mfma_f32_16x16x32_bf16 v[40:43], v[68:71], v[84:87], v[40:43]
    v_mfma_f32_16x16x32_bf16 v[40:43], v[72:75], v[80:83], v[40:43]
    s_nop 3
    ds_write_b128 v112, v[44:47] offset:37888
    v_mfma_f32_16x16x32_bf16 v[36:39], v[56:59], v[92:95], v[36:39]
    v_mfma_f32_16x16x32_bf16 v[36:39], v[60:63], v[88:91], v[36:39]
    v_mfma_f32_16x16x32_bf16 v[36:39], v[64:67], v[84:87], v[36:39]
    v_mfma_f32_16x16x32_bf16 v[36:39], v[68:71], v[80:83], v[36:39]
    ds_write_b128 v112, v[40:43] offset:36864
    v_mfma_f32_16x16x32_bf16 v[32:35], v[52:55], v[92:95], v[32:35]
    v_mfma_f32_16x16x32_bf16 v[32:35], v[56:59], v[88:91], v[32:35]
    v_mfma_f32_16x16x32_bf16 v[32:35], v[60:63], v[84:87], v[32:35]
    v_mfma_f32_16x16x32_bf16 v[32:35], v[64:67], v[80:83], v[32:35]
    s_nop 2
    ds_write_b128 v112, v[36:39] offset:25600
    v_mfma_f32_16x16x32_bf16 v[28:31], v[48:51], v[92:95], v[28:31]
    v_mfma_f32_16x16x32_bf16 v[28:31], v[52:55], v[88:91], v[28:31]
    v_mfma_f32_16x16x32_bf16 v[28:31], v[56:59], v[84:87], v[28:31]
    v_mfma_f32_16x16x32_bf16 v[28:31], v[60:63], v[80:83], v[28:31]
    ds_write_b128 v112, v[32:35] offset:24576
    v_mfma_f32_16x16x32_bf16 v[24:27], v[48:51], v[88:91], v[24:27]
    v_mfma_f32_16x16x32_bf16 v[24:27], v[52:55], v[84:87], v[24:27]
    v_mfma_f32_16x16x32_bf16 v[24:27], v[56:59], v[80:83], v[24:27]
    s_nop 3
    ds_write_b128 v112, v[28:31] offset:13312
    v_mfma_f32_16x16x32_bf16 v[20:23], v[48:51], v[84:87], v[20:23]
    v_mfma_f32_16x16x32_bf16 v[20:23], v[52:55], v[80:83], v[20:23]
    s_nop 0
    ds_write_b128 v112, v[24:27] offset:12288
    v_mfma_f32_16x16x32_bf16 v[16:19], v[48:51], v[80:83], v[16:19]
    ds_read_b64 v[72:73], v114 offset:3584
    ds_read_b64 v[74:75], v114 offset:3072
    s_waitcnt lgkmcnt(0)
    s_barrier
    ds_read_b128 v[48:51], v112 offset:0
    ds_read_b128 v[52:55], v112 offset:2048
    ds_read_b128 v[56:59], v112 offset:4096
    ds_read_b128 v[60:63], v112 offset:1024
    ds_read_b128 v[64:67], v112 offset:3072
    ds_read_b128 v[68:71], v112 offset:5120
    v_lshlrev_b32 v79, 16, v72
    v_and_b32 v78, 0xffff0000, v72
    v_lshlrev_b32 v77, 16, v73
    v_and_b32 v76, 0xffff0000, v73
    v_mul_f32 v76, s68, v76
    v_mul_f32 v77, s68, v77
    v_mul_f32 v78, s68, v78
    v_mul_f32 v79, s68, v79
    v_cvt_pk_bf16_f32 v80, v76, v77
    v_lshlrev_b32 v76, 16, v80
    v_and_b32 v77, 0xffff0000, v80
    v_cvt_pk_bf16_f32 v80, v78, v79
    v_lshlrev_b32 v78, 16, v80
    v_and_b32 v79, 0xffff0000, v80
    s_waitcnt lgkmcnt(3)
    v_add_f32 v16, v16, v48
    v_add_f32 v52, v52, v56
    v_add_f32 v17, v17, v49
    v_add_f32 v53, v53, v57
    v_add_f32 v18, v18, v50
    v_add_f32 v54, v54, v58
    v_add_f32 v19, v19, v51
    v_add_f32 v55, v55, v59
    v_add_f32 v16, v16, v52
    v_add_f32 v17, v17, v53
    v_add_f32 v18, v18, v54
    v_add_f32 v19, v19, v55
    v_cvt_pk_bf16_f32 v80, v16, v17
    v_lshlrev_b32 v16, 16, v80
    v_and_b32 v17, 0xffff0000, v80
    v_cvt_pk_bf16_f32 v80, v18, v19
    v_lshlrev_b32 v18, 16, v80
    v_and_b32 v19, 0xffff0000, v80
    v_add_f32 v16, v16, v76
    v_add_f32 v17, v17, v77
    v_add_f32 v18, v18, v78
    v_add_f32 v19, v19, v79
    v_cvt_pk_bf16_f32 v82, v16, v17
    v_cvt_pk_bf16_f32 v83, v18, v19
    buffer_store_dwordx2 v[82:83], v113, s[60:63], s67 offen offset:0 sc1
    v_lshlrev_b32 v79, 16, v74
    v_and_b32 v78, 0xffff0000, v74
    v_lshlrev_b32 v77, 16, v75
    v_and_b32 v76, 0xffff0000, v75
    v_mul_f32 v76, s68, v76
    v_mul_f32 v77, s68, v77
    v_mul_f32 v78, s68, v78
    v_mul_f32 v79, s68, v79
    v_cvt_pk_bf16_f32 v80, v76, v77
    v_lshlrev_b32 v76, 16, v80
    v_and_b32 v77, 0xffff0000, v80
    v_cvt_pk_bf16_f32 v80, v78, v79
    v_lshlrev_b32 v78, 16, v80
    v_and_b32 v79, 0xffff0000, v80
    s_waitcnt lgkmcnt(0)
    v_add_f32 v20, v20, v60
    v_add_f32 v64, v64, v68
    v_add_f32 v21, v21, v61
    v_add_f32 v65, v65, v69
    v_add_f32 v22, v22, v62
    v_add_f32 v66, v66, v70
    v_add_f32 v23, v23, v63
    v_add_f32 v67, v67, v71
    v_add_f32 v20, v20, v64
    v_add_f32 v21, v21, v65
    v_add_f32 v22, v22, v66
    v_add_f32 v23, v23, v67
    v_cvt_pk_bf16_f32 v80, v20, v21
    v_lshlrev_b32 v20, 16, v80
    v_and_b32 v21, 0xffff0000, v80
    v_cvt_pk_bf16_f32 v80, v22, v23
    v_lshlrev_b32 v22, 16, v80
    v_and_b32 v23, 0xffff0000, v80
    v_add_f32 v20, v20, v76
    v_add_f32 v21, v21, v77
    v_add_f32 v22, v22, v78
    v_add_f32 v23, v23, v79
    v_cvt_pk_bf16_f32 v84, v20, v21
    v_cvt_pk_bf16_f32 v85, v22, v23
    buffer_store_dwordx2 v[84:85], v113, s[60:63], s67 offen offset:512 sc1
    s_nop 0
    s_branch m_p1j
m_p1r1:
    v_mfma_f32_16x16x32_bf16 v[44:47], v[64:67], v[92:95], v[44:47]
    v_mfma_f32_16x16x32_bf16 v[44:47], v[68:71], v[88:91], v[44:47]
    v_mfma_f32_16x16x32_bf16 v[44:47], v[72:75], v[84:87], v[44:47]
    v_mfma_f32_16x16x32_bf16 v[44:47], v[76:79], v[80:83], v[44:47]
    v_mfma_f32_16x16x32_bf16 v[40:43], v[60:63], v[92:95], v[40:43]
    v_mfma_f32_16x16x32_bf16 v[40:43], v[64:67], v[88:91], v[40:43]
    v_mfma_f32_16x16x32_bf16 v[40:43], v[68:71], v[84:87], v[40:43]
    v_mfma_f32_16x16x32_bf16 v[40:43], v[72:75], v[80:83], v[40:43]
    s_nop 3
    ds_write_b128 v112, v[44:47] offset:39936
    v_mfma_f32_16x16x32_bf16 v[36:39], v[56:59], v[92:95], v[36:39]
    v_mfma_f32_16x16x32_bf16 v[36:39], v[60:63], v[88:91], v[36:39]
    v_mfma_f32_16x16x32_bf16 v[36:39], v[64:67], v[84:87], v[36:39]
    v_mfma_f32_16x16x32_bf16 v[36:39], v[68:71], v[80:83], v[36:39]
    ds_write_b128 v112, v[40:43] offset:38912
    v_mfma_f32_16x16x32_bf16 v[32:35], v[52:55], v[92:95], v[32:35]
    v_mfma_f32_16x16x32_bf16 v[32:35], v[56:59], v[88:91], v[32:35]
    v_mfma_f32_16x16x32_bf16 v[32:35], v[60:63], v[84:87], v[32:35]
    v_mfma_f32_16x16x32_bf16 v[32:35], v[64:67], v[80:83], v[32:35]
    s_nop 2
    ds_write_b128 v112, v[36:39] offset:27648
    v_mfma_f32_16x16x32_bf16 v[20:23], v[48:51], v[84:87], v[20:23]
    v_mfma_f32_16x16x32_bf16 v[20:23], v[52:55], v[80:83], v[20:23]
    s_nop 1
    ds_write_b128 v112, v[32:35] offset:26624
    v_mfma_f32_16x16x32_bf16 v[16:19], v[48:51], v[80:83], v[16:19]
    s_nop 3
    ds_write_b128 v112, v[20:23] offset:1024
    v_mfma_f32_16x16x32_bf16 v[28:31], v[48:51], v[92:95], v[28:31]
    v_mfma_f32_16x16x32_bf16 v[28:31], v[52:55], v[88:91], v[28:31]
    v_mfma_f32_16x16x32_bf16 v[28:31], v[56:59], v[84:87], v[28:31]
    v_mfma_f32_16x16x32_bf16 v[28:31], v[60:63], v[80:83], v[28:31]
    ds_write_b128 v112, v[16:19] offset:0
    v_mfma_f32_16x16x32_bf16 v[24:27], v[48:51], v[88:91], v[24:27]
    v_mfma_f32_16x16x32_bf16 v[24:27], v[52:55], v[84:87], v[24:27]
    v_mfma_f32_16x16x32_bf16 v[24:27], v[56:59], v[80:83], v[24:27]
    ds_read_b64 v[72:73], v114 offset:2560
    ds_read_b64 v[74:75], v114 offset:2048
    s_waitcnt lgkmcnt(0)
    s_barrier
    ds_read_b128 v[48:51], v112 offset:12288
    ds_read_b128 v[52:55], v112 offset:14336
    ds_read_b128 v[56:59], v112 offset:16384
    ds_read_b128 v[60:63], v112 offset:13312
    ds_read_b128 v[64:67], v112 offset:15360
    ds_read_b128 v[68:71], v112 offset:17408
    v_lshlrev_b32 v79, 16, v72
    v_and_b32 v78, 0xffff0000, v72
    v_lshlrev_b32 v77, 16, v73
    v_and_b32 v76, 0xffff0000, v73
    v_mul_f32 v76, s68, v76
    v_mul_f32 v77, s68, v77
    v_mul_f32 v78, s68, v78
    v_mul_f32 v79, s68, v79
    v_cvt_pk_bf16_f32 v80, v76, v77
    v_lshlrev_b32 v76, 16, v80
    v_and_b32 v77, 0xffff0000, v80
    v_cvt_pk_bf16_f32 v80, v78, v79
    v_lshlrev_b32 v78, 16, v80
    v_and_b32 v79, 0xffff0000, v80
    s_waitcnt lgkmcnt(3)
    v_add_f32 v24, v24, v48
    v_add_f32 v52, v52, v56
    v_add_f32 v25, v25, v49
    v_add_f32 v53, v53, v57
    v_add_f32 v26, v26, v50
    v_add_f32 v54, v54, v58
    v_add_f32 v27, v27, v51
    v_add_f32 v55, v55, v59
    v_add_f32 v24, v24, v52
    v_add_f32 v25, v25, v53
    v_add_f32 v26, v26, v54
    v_add_f32 v27, v27, v55
    v_cvt_pk_bf16_f32 v80, v24, v25
    v_lshlrev_b32 v24, 16, v80
    v_and_b32 v25, 0xffff0000, v80
    v_cvt_pk_bf16_f32 v80, v26, v27
    v_lshlrev_b32 v26, 16, v80
    v_and_b32 v27, 0xffff0000, v80
    v_add_f32 v24, v24, v76
    v_add_f32 v25, v25, v77
    v_add_f32 v26, v26, v78
    v_add_f32 v27, v27, v79
    v_cvt_pk_bf16_f32 v82, v24, v25
    v_cvt_pk_bf16_f32 v83, v26, v27
    buffer_store_dwordx2 v[82:83], v113, s[60:63], s67 offen offset:1024 sc1
    v_lshlrev_b32 v79, 16, v74
    v_and_b32 v78, 0xffff0000, v74
    v_lshlrev_b32 v77, 16, v75
    v_and_b32 v76, 0xffff0000, v75
    v_mul_f32 v76, s68, v76
    v_mul_f32 v77, s68, v77
    v_mul_f32 v78, s68, v78
    v_mul_f32 v79, s68, v79
    v_cvt_pk_bf16_f32 v80, v76, v77
    v_lshlrev_b32 v76, 16, v80
    v_and_b32 v77, 0xffff0000, v80
    v_cvt_pk_bf16_f32 v80, v78, v79
    v_lshlrev_b32 v78, 16, v80
    v_and_b32 v79, 0xffff0000, v80
    s_waitcnt lgkmcnt(0)
    v_add_f32 v28, v28, v60
    v_add_f32 v64, v64, v68
    v_add_f32 v29, v29, v61
    v_add_f32 v65, v65, v69
    v_add_f32 v30, v30, v62
    v_add_f32 v66, v66, v70
    v_add_f32 v31, v31, v63
    v_add_f32 v67, v67, v71
    v_add_f32 v28, v28, v64
    v_add_f32 v29, v29, v65
    v_add_f32 v30, v30, v66
    v_add_f32 v31, v31, v67
    v_cvt_pk_bf16_f32 v80, v28, v29
    v_lshlrev_b32 v28, 16, v80
    v_and_b32 v29, 0xffff0000, v80
    v_cvt_pk_bf16_f32 v80, v30, v31
    v_lshlrev_b32 v30, 16, v80
    v_and_b32 v31, 0xffff0000, v80
    v_add_f32 v28, v28, v76
    v_add_f32 v29, v29, v77
    v_add_f32 v30, v30, v78
    v_add_f32 v31, v31, v79
    v_cvt_pk_bf16_f32 v84, v28, v29
    v_cvt_pk_bf16_f32 v85, v30, v31
    buffer_store_dwordx2 v[84:85], v113, s[60:63], s67 offen offset:1536 sc1
    s_nop 0
    s_branch m_p1j
m_p1r2:
    v_mfma_f32_16x16x32_bf16 v[44:47], v[64:67], v[92:95], v[44:47]
    v_mfma_f32_16x16x32_bf16 v[44:47], v[68:71], v[88:91], v[44:47]
    v_mfma_f32_16x16x32_bf16 v[44:47], v[72:75], v[84:87], v[44:47]
    v_mfma_f32_16x16x32_bf16 v[44:47], v[76:79], v[80:83], v[44:47]
    v_mfma_f32_16x16x32_bf16 v[40:43], v[60:63], v[92:95], v[40:43]
    v_mfma_f32_16x16x32_bf16 v[40:43], v[64:67], v[88:91], v[40:43]
    v_mfma_f32_16x16x32_bf16 v[40:43], v[68:71], v[84:87], v[40:43]
    v_mfma_f32_16x16x32_bf16 v[40:43], v[72:75], v[80:83], v[40:43]
    s_nop 3
    ds_write_b128 v112, v[44:47] offset:41984
    v_mfma_f32_16x16x32_bf16 v[28:31], v[48:51], v[92:95], v[28:31]
    v_mfma_f32_16x16x32_bf16 v[28:31], v[52:55], v[88:91], v[28:31]
    v_mfma_f32_16x16x32_bf16 v[28:31], v[56:59], v[84:87], v[28:31]
    v_mfma_f32_16x16x32_bf16 v[28:31], v[60:63], v[80:83], v[28:31]
    ds_write_b128 v112, v[40:43] offset:40960
    v_mfma_f32_16x16x32_bf16 v[24:27], v[48:51], v[88:91], v[24:27]
    v_mfma_f32_16x16x32_bf16 v[24:27], v[52:55], v[84:87], v[24:27]
    v_mfma_f32_16x16x32_bf16 v[24:27], v[56:59], v[80:83], v[24:27]
    s_nop 3
    ds_write_b128 v112, v[28:31] offset:15360
    v_mfma_f32_16x16x32_bf16 v[20:23], v[48:51], v[84:87], v[20:23]
    v_mfma_f32_16x16x32_bf16 v[20:23], v[52:55], v[80:83], v[20:23]
    s_nop 0
    ds_write_b128 v112, v[24:27] offset:14336
    v_mfma_f32_16x16x32_bf16 v[16:19], v[48:51], v[80:83], v[16:19]
    s_nop 4
    ds_write_b128 v112, v[20:23] offset:3072
    v_mfma_f32_16x16x32_bf16 v[36:39], v[56:59], v[92:95], v[36:39]
    v_mfma_f32_16x16x32_bf16 v[36:39], v[60:63], v[88:91], v[36:39]
    v_mfma_f32_16x16x32_bf16 v[36:39], v[64:67], v[84:87], v[36:39]
    v_mfma_f32_16x16x32_bf16 v[36:39], v[68:71], v[80:83], v[36:39]
    ds_write_b128 v112, v[16:19] offset:2048
    v_mfma_f32_16x16x32_bf16 v[32:35], v[52:55], v[92:95], v[32:35]
    v_mfma_f32_16x16x32_bf16 v[32:35], v[56:59], v[88:91], v[32:35]
    v_mfma_f32_16x16x32_bf16 v[32:35], v[60:63], v[84:87], v[32:35]
    v_mfma_f32_16x16x32_bf16 v[32:35], v[64:67], v[80:83], v[32:35]
    ds_read_b64 v[72:73], v114 offset:1536
    ds_read_b64 v[74:75], v114 offset:1024
    s_waitcnt lgkmcnt(0)
    s_barrier
    ds_read_b128 v[48:51], v112 offset:24576
    ds_read_b128 v[52:55], v112 offset:26624
    ds_read_b128 v[56:59], v112 offset:28672
    ds_read_b128 v[60:63], v112 offset:25600
    ds_read_b128 v[64:67], v112 offset:27648
    ds_read_b128 v[68:71], v112 offset:29696
    v_lshlrev_b32 v79, 16, v72
    v_and_b32 v78, 0xffff0000, v72
    v_lshlrev_b32 v77, 16, v73
    v_and_b32 v76, 0xffff0000, v73
    v_mul_f32 v76, s68, v76
    v_mul_f32 v77, s68, v77
    v_mul_f32 v78, s68, v78
    v_mul_f32 v79, s68, v79
    v_cvt_pk_bf16_f32 v80, v76, v77
    v_lshlrev_b32 v76, 16, v80
    v_and_b32 v77, 0xffff0000, v80
    v_cvt_pk_bf16_f32 v80, v78, v79
    v_lshlrev_b32 v78, 16, v80
    v_and_b32 v79, 0xffff0000, v80
    s_waitcnt lgkmcnt(3)
    v_add_f32 v32, v32, v48
    v_add_f32 v52, v52, v56
    v_add_f32 v33, v33, v49
    v_add_f32 v53, v53, v57
    v_add_f32 v34, v34, v50
    v_add_f32 v54, v54, v58
    v_add_f32 v35, v35, v51
    v_add_f32 v55, v55, v59
    v_add_f32 v32, v32, v52
    v_add_f32 v33, v33, v53
    v_add_f32 v34, v34, v54
    v_add_f32 v35, v35, v55
    v_cvt_pk_bf16_f32 v80, v32, v33
    v_lshlrev_b32 v32, 16, v80
    v_and_b32 v33, 0xffff0000, v80
    v_cvt_pk_bf16_f32 v80, v34, v35
    v_lshlrev_b32 v34, 16, v80
    v_and_b32 v35, 0xffff0000, v80
    v_add_f32 v32, v32, v76
    v_add_f32 v33, v33, v77
    v_add_f32 v34, v34, v78
    v_add_f32 v35, v35, v79
    v_cvt_pk_bf16_f32 v82, v32, v33
    v_cvt_pk_bf16_f32 v83, v34, v35
    buffer_store_dwordx2 v[82:83], v113, s[60:63], s67 offen offset:2048 sc1
    v_lshlrev_b32 v79, 16, v74
    v_and_b32 v78, 0xffff0000, v74
    v_lshlrev_b32 v77, 16, v75
    v_and_b32 v76, 0xffff0000, v75
    v_mul_f32 v76, s68, v76
    v_mul_f32 v77, s68, v77
    v_mul_f32 v78, s68, v78
    v_mul_f32 v79, s68, v79
    v_cvt_pk_bf16_f32 v80, v76, v77
    v_lshlrev_b32 v76, 16, v80
    v_and_b32 v77, 0xffff0000, v80
    v_cvt_pk_bf16_f32 v80, v78, v79
    v_lshlrev_b32 v78, 16, v80
    v_and_b32 v79, 0xffff0000, v80
    s_waitcnt lgkmcnt(0)
    v_add_f32 v36, v36, v60
    v_add_f32 v64, v64, v68
    v_add_f32 v37, v37, v61
    v_add_f32 v65, v65, v69
    v_add_f32 v38, v38, v62
    v_add_f32 v66, v66, v70
    v_add_f32 v39, v39, v63
    v_add_f32 v67, v67, v71
    v_add_f32 v36, v36, v64
    v_add_f32 v37, v37, v65
    v_add_f32 v38, v38, v66
    v_add_f32 v39, v39, v67
    v_cvt_pk_bf16_f32 v80, v36, v37
    v_lshlrev_b32 v36, 16, v80
    v_and_b32 v37, 0xffff0000, v80
    v_cvt_pk_bf16_f32 v80, v38, v39
    v_lshlrev_b32 v38, 16, v80
    v_and_b32 v39, 0xffff0000, v80
    v_add_f32 v36, v36, v76
    v_add_f32 v37, v37, v77
    v_add_f32 v38, v38, v78
    v_add_f32 v39, v39, v79
    v_cvt_pk_bf16_f32 v84, v36, v37
    v_cvt_pk_bf16_f32 v85, v38, v39
    buffer_store_dwordx2 v[84:85], v113, s[60:63], s67 offen offset:2560 sc1
    s_nop 0
    s_branch m_p1j
m_p1r3:
    v_mfma_f32_16x16x32_bf16 v[36:39], v[56:59], v[92:95], v[36:39]
    v_mfma_f32_16x16x32_bf16 v[36:39], v[60:63], v[88:91], v[36:39]
    v_mfma_f32_16x16x32_bf16 v[36:39], v[64:67], v[84:87], v[36:39]
    v_mfma_f32_16x16x32_bf16 v[36:39], v[68:71], v[80:83], v[36:39]
    v_mfma_f32_16x16x32_bf16 v[32:35], v[52:55], v[92:95], v[32:35]
    v_mfma_f32_16x16x32_bf16 v[32:35], v[56:59], v[88:91], v[32:35]
    v_mfma_f32_16x16x32_bf16 v[32:35], v[60:63], v[84:87], v[32:35]
    v_mfma_f32_16x16x32_bf16 v[32:35], v[64:67], v[80:83], v[32:35]
    s_nop 3
    ds_write_b128 v112, v[36:39] offset:29696
    v_mfma_f32_16x16x32_bf16 v[28:31], v[48:51], v[92:95], v[28:31]
    v_mfma_f32_16x16x32_bf16 v[28:31], v[52:55], v[88:91], v[28:31]
    v_mfma_f32_16x16x32_bf16 v[28:31], v[56:59], v[84:87], v[28:31]
    v_mfma_f32_16x16x32_bf16 v[28:31], v[60:63], v[80:83], v[28:31]
    ds_write_b128 v112, v[32:35] offset:28672
    v_mfma_f32_16x16x32_bf16 v[24:27], v[48:51], v[88:91], v[24:27]
    v_mfma_f32_16x16x32_bf16 v[24:27], v[52:55], v[84:87], v[24:27]
    v_mfma_f32_16x16x32_bf16 v[24:27], v[56:59], v[80:83], v[24:27]
    s_nop 3
    ds_write_b128 v112, v[28:31] offset:17408
    v_mfma_f32_16x16x32_bf16 v[20:23], v[48:51], v[84:87], v[20:23]
    v_mfma_f32_16x16x32_bf16 v[20:23], v[52:55], v[80:83], v[20:23]
    s_nop 0
    ds_write_b128 v112, v[24:27] offset:16384
    v_mfma_f32_16x16x32_bf16 v[16:19], v[48:51], v[80:83], v[16:19]
    s_nop 4
    ds_write_b128 v112, v[20:23] offset:5120
    v_mfma_f32_16x16x32_bf16 v[44:47], v[64:67], v[92:95], v[44:47]
    v_mfma_f32_16x16x32_bf16 v[44:47], v[68:71], v[88:91], v[44:47]
    v_mfma_f32_16x16x32_bf16 v[44:47], v[72:75], v[84:87], v[44:47]
    v_mfma_f32_16x16x32_bf16 v[44:47], v[76:79], v[80:83], v[44:47]
    ds_write_b128 v112, v[16:19] offset:4096
    v_mfma_f32_16x16x32_bf16 v[40:43], v[60:63], v[92:95], v[40:43]
    v_mfma_f32_16x16x32_bf16 v[40:43], v[64:67], v[88:91], v[40:43]
    v_mfma_f32_16x16x32_bf16 v[40:43], v[68:71], v[84:87], v[40:43]
    v_mfma_f32_16x16x32_bf16 v[40:43], v[72:75], v[80:83], v[40:43]
    ds_read_b64 v[72:73], v114 offset:512
    ds_read_b64 v[74:75], v114 offset:0
    s_waitcnt lgkmcnt(0)
    s_barrier
    ds_read_b128 v[48:51], v112 offset:36864
    ds_read_b128 v[52:55], v112 offset:38912
    ds_read_b128 v[56:59], v112 offset:40960
    ds_read_b128 v[60:63], v112 offset:37888
    ds_read_b128 v[64:67], v112 offset:39936
    ds_read_b128 v[68:71], v112 offset:41984
    v_lshlrev_b32 v79, 16, v72
    v_and_b32 v78, 0xffff0000, v72
    v_lshlrev_b32 v77, 16, v73
    v_and_b32 v76, 0xffff0000, v73
    v_mul_f32 v76, s68, v76
    v_mul_f32 v77, s68, v77
    v_mul_f32 v78, s68, v78
    v_mul_f32 v79, s68, v79
    v_cvt_pk_bf16_f32 v80, v76, v77
    v_lshlrev_b32 v76, 16, v80
    v_and_b32 v77, 0xffff0000, v80
    v_cvt_pk_bf16_f32 v80, v78, v79
    v_lshlrev_b32 v78, 16, v80
    v_and_b32 v79, 0xffff0000, v80
    s_waitcnt lgkmcnt(3)
    v_add_f32 v40, v40, v48
    v_add_f32 v52, v52, v56
    v_add_f32 v41, v41, v49
    v_add_f32 v53, v53, v57
    v_add_f32 v42, v42, v50
    v_add_f32 v54, v54, v58
    v_add_f32 v43, v43, v51
    v_add_f32 v55, v55, v59
    v_add_f32 v40, v40, v52
    v_add_f32 v41, v41, v53
    v_add_f32 v42, v42, v54
    v_add_f32 v43, v43, v55
    v_cvt_pk_bf16_f32 v80, v40, v41
    v_lshlrev_b32 v40, 16, v80
    v_and_b32 v41, 0xffff0000, v80
    v_cvt_pk_bf16_f32 v80, v42, v43
    v_lshlrev_b32 v42, 16, v80
    v_and_b32 v43, 0xffff0000, v80
    v_add_f32 v40, v40, v76
    v_add_f32 v41, v41, v77
    v_add_f32 v42, v42, v78
    v_add_f32 v43, v43, v79
    v_cvt_pk_bf16_f32 v82, v40, v41
    v_cvt_pk_bf16_f32 v83, v42, v43
    buffer_store_dwordx2 v[82:83], v113, s[60:63], s67 offen offset:3072 sc1
    v_lshlrev_b32 v79, 16, v74
    v_and_b32 v78, 0xffff0000, v74
    v_lshlrev_b32 v77, 16, v75
    v_and_b32 v76, 0xffff0000, v75
    v_mul_f32 v76, s68, v76
    v_mul_f32 v77, s68, v77
    v_mul_f32 v78, s68, v78
    v_mul_f32 v79, s68, v79
    v_cvt_pk_bf16_f32 v80, v76, v77
    v_lshlrev_b32 v76, 16, v80
    v_and_b32 v77, 0xffff0000, v80
    v_cvt_pk_bf16_f32 v80, v78, v79
    v_lshlrev_b32 v78, 16, v80
    v_and_b32 v79, 0xffff0000, v80
    s_waitcnt lgkmcnt(0)
    v_add_f32 v44, v44, v60
    v_add_f32 v64, v64, v68
    v_add_f32 v45, v45, v61
    v_add_f32 v65, v65, v69
    v_add_f32 v46, v46, v62
    v_add_f32 v66, v66, v70
    v_add_f32 v47, v47, v63
    v_add_f32 v67, v67, v71
    v_add_f32 v44, v44, v64
    v_add_f32 v45, v45, v65
    v_add_f32 v46, v46, v66
    v_add_f32 v47, v47, v67
    v_cvt_pk_bf16_f32 v80, v44, v45
    v_lshlrev_b32 v44, 16, v80
    v_and_b32 v45, 0xffff0000, v80
    v_cvt_pk_bf16_f32 v80, v46, v47
    v_lshlrev_b32 v46, 16, v80
    v_and_b32 v47, 0xffff0000, v80
    v_add_f32 v44, v44, v76
    v_add_f32 v45, v45, v77
    v_add_f32 v46, v46, v78
    v_add_f32 v47, v47, v79
    v_cvt_pk_bf16_f32 v84, v44, v45
    v_cvt_pk_bf16_f32 v85, v46, v47
    buffer_store_dwordx2 v[84:85], v113, s[60:63], s67 offen offset:3584 sc1
    s_nop 0
m_p1j:
    s_cmp_lg_u32 s3, 0
    s_cbranch_scc1 m_wd5
    s_lshl_b32 s10, s5, 2
    v_add_u32 v8, 0, v2
    v_min_u32 v8, 3, v8
    v_add_u32 v8, s10, v8
    v_max_i32 v8, 0, v8
    v_lshlrev_b32 v8, 7, v8
    s_mov_b32 s10, 9469952
    s_mov_b32 s11, 0
    buffer_load_dwordx2 v[96:97], v8, s[60:63], s10 offen sc1
    s_sleep 2
m_wl5:
    buffer_load_dwordx2 v[100:101], v8, s[60:63], s10 offen sc1
    s_waitcnt vmcnt(1)
    v_xor_b32 v96, s56, v96
    v_xor_b32 v97, s57, v97
    v_lshrrev_b32 v98, 8, v97
    v_or_b32 v98, v98, v96
    v_cmp_ne_u32 vcc, 0, v98
    s_nop 4
    s_cbranch_vccz m_wa5
    buffer_load_dwordx2 v[96:97], v8, s[60:63], s10 offen sc1
    s_waitcnt vmcnt(1)
    v_xor_b32 v100, s56, v100
    v_xor_b32 v101, s57, v101
    v_lshrrev_b32 v102, 8, v101
    v_or_b32 v102, v102, v100
    v_cmp_ne_u32 vcc, 0, v102
    s_nop 4
    s_cbranch_vccz m_wb5
    s_add_u32 s11, s11, 1
    s_cmp_gt_u32 s11, 200000
    s_cbranch_scc0 m_wl5
    s_branch m_wb5
m_wa5:
m_wb5:
m_wd5:
    s_waitcnt vmcnt(0)
    s_barrier
    s_cmp_lg_u32 s3, 0
    s_cbranch_scc1 m_sig6
    s_lshl_b32 s10, s2, 7
    s_add_u32 s10, s10, 9502720
    v_mov_b32 v10, 0
    v_mov_b32 v8, s56
    v_mov_b32 v9, s57
    s_mov_b64 exec, 1
    buffer_store_dwordx2 v[8:9], v10, s[60:63], s10 offen sc1
    s_mov_b64 exec, -1
m_sig6:
    s_branch m_nop1b
m_nop1:
    s_sub_u32 s10, s2, 224
    s_and_b32 s64, s10, 7
    s_lshr_b32 s65, s10, 3
    s_mov_b32 s48, s30
    s_mov_b32 s49, s31
    s_mov_b32 s50, 1204224
    s_mov_b32 s51, 0x00020000
    s_mul_i32 s66, s64, 224
    s_mul_i32 s11, s65, 172032
    s_add_u32 s66, s66, s11
    s_lshl_b32 s68, s3, 10
    s_mul_i32 s69, s64, -112
    s_add_u32 s69, s69, 1568
    s_movk_i32 s58, 2352
    s_mov_b32 s59, 430080
    v_mov_b32 v120, v0
    v_mul_u32_u24 v121, 3121, v120
    v_lshrrev_b32 v121, 16, v121
    v_mul_u32_u24 v122, 21, v121
    v_sub_u32 v122, v120, v122
    v_add_u32 v122, 18, v122
    v_lshrrev_b32 v122, 5, v122
    v_mul_u32_u24 v122, s69, v122
    v_mad_u32_u24 v122, v121, s58, v122
    v_lshrrev_b32 v121, 6, v121
    v_mad_u32_u24 v122, v121, s59, v122
    v_lshl_add_u32 v122, v120, 4, v122
    s_mov_b32 m0, s68
    s_nop 0
    buffer_load_dwordx4 v122, s[48:51], s66 offen lds
    v_add_u32 v120, 512, v120
    s_add_u32 s68, s68, 8192
    v_mul_u32_u24 v121, 3121, v120
    v_lshrrev_b32 v121, 16, v121
    v_mul_u32_u24 v122, 21, v121
    v_sub_u32 v122, v120, v122
    v_add_u32 v122, 18, v122
    v_lshrrev_b32 v122, 5, v122
    v_mul_u32_u24 v122, s69, v122
    v_mad_u32_u24 v122, v121, s58, v122
    v_lshrrev_b32 v121, 6, v121
    v_mad_u32_u24 v122, v121, s59, v122
    v_lshl_add_u32 v122, v120, 4, v122
    s_mov_b32 m0, s68
    s_nop 0
    buffer_load_dwordx4 v122, s[48:51], s66 offen lds
    v_add_u32 v120, 512, v120
    s_add_u32 s68, s68, 8192
    v_mul_u32_u24 v121, 3121, v120
    v_lshrrev_b32 v121, 16, v121
    v_mul_u32_u24 v122, 21, v121
    v_sub_u32 v122, v120, v122
    v_add_u32 v122, 18, v122
    v_lshrrev_b32 v122, 5, v122
    v_mul_u32_u24 v122, s69, v122
    v_mad_u32_u24 v122, v121, s58, v122
    v_lshrrev_b32 v121, 6, v121
    v_mad_u32_u24 v122, v121, s59, v122
    v_lshl_add_u32 v122, v120, 4, v122
    s_mov_b32 m0, s68
    s_nop 0
    buffer_load_dwordx4 v122, s[48:51], s66 offen lds
    v_add_u32 v120, 512, v120
    s_add_u32 s68, s68, 8192
    v_mul_u32_u24 v121, 3121, v120
    v_lshrrev_b32 v121, 16, v121
    v_mul_u32_u24 v122, 21, v121
    v_sub_u32 v122, v120, v122
    v_add_u32 v122, 18, v122
    v_lshrrev_b32 v122, 5, v122
    v_mul_u32_u24 v122, s69, v122
    v_mad_u32_u24 v122, v121, s58, v122
    v_lshrrev_b32 v121, 6, v121
    v_mad_u32_u24 v122, v121, s59, v122
    v_lshl_add_u32 v122, v120, 4, v122
    s_mov_b32 m0, s68
    s_nop 0
    buffer_load_dwordx4 v122, s[48:51], s66 offen lds
    v_add_u32 v120, 512, v120
    s_add_u32 s68, s68, 8192
    v_mul_u32_u24 v121, 3121, v120
    v_lshrrev_b32 v121, 16, v121
    v_mul_u32_u24 v122, 21, v121
    v_sub_u32 v122, v120, v122
    v_add_u32 v122, 18, v122
    v_lshrrev_b32 v122, 5, v122
    v_mul_u32_u24 v122, s69, v122
    v_mad_u32_u24 v122, v121, s58, v122
    v_lshrrev_b32 v121, 6, v121
    v_mad_u32_u24 v122, v121, s59, v122
    v_lshl_add_u32 v122, v120, 4, v122
    s_mov_b32 m0, s68
    s_nop 0
    buffer_load_dwordx4 v122, s[48:51], s66 offen lds
    v_add_u32 v120, 512, v120
    s_add_u32 s68, s68, 8192
    v_mul_u32_u24 v121, 3121, v120
    v_lshrrev_b32 v121, 16, v121
    v_mul_u32_u24 v122, 21, v121
    v_sub_u32 v122, v120, v122
    v_add_u32 v122, 18, v122
    v_lshrrev_b32 v122, 5, v122
    v_mul_u32_u24 v122, s69, v122
    v_mad_u32_u24 v122, v121, s58, v122
    v_lshrrev_b32 v121, 6, v121
    v_mad_u32_u24 v122, v121, s59, v122
    v_lshl_add_u32 v122, v120, 4, v122
    s_mov_b32 m0, s68
    s_nop 0
    buffer_load_dwordx4 v122, s[48:51], s66 offen lds
    v_bfe_u32 v123, v2, 2, 2
    v_lshl_add_u32 v123, v4, 3, v123
    v_mul_u32_u24 v123, 336, v123
    v_and_b32 v124, 3, v2
    v_lshl_add_u32 v123, v124, 4, v123
    s_mul_i32 s10, s7, 21504
    s_lshr_b32 s11, s6, 1
    s_mul_i32 s11, s11, 56
    s_and_b32 s12, s6, 1
    s_lshl_b32 s13, s12, 3
    s_add_u32 s11, s11, s13
    s_add_u32 s11, s11, s10
    s_add_u32 s11, s11, 224
    v_add_u32 v125, s11, v123
    s_mul_i32 s11, s6, 56
    s_add_u32 s11, s11, s10
    v_add_u32 v123, s11, v123
    v_add_u32 v124, 8, v123
    v_subrev_u32 v126, 12, v3
    v_ashrrev_i32 v126, 31, v126
    s_sub_u32 s12, s12, 1
    v_or_b32 v127, s12, v126
    v_mov_b32 v72, s78
    v_mov_b32 v73, s78
    v_mov_b32 v74, s78
    v_mov_b32 v75, s78
    s_lshl_b32 s10, s64, 2
    s_add_u32 s10, s10, s6
    s_mul_i32 s70, s10, 43008
    s_mul_i32 s11, s7, 7168
    s_add_u32 s70, s70, s11
    s_lshl_b32 s11, s65, 11
    s_add_u32 s70, s70, s11
    s_add_u32 s70, s70, 6291456
    s_cmp_eq_u32 s65, 3
    s_cselect_b32 s71, 0x40000000, s70
    s_cselect_b32 s72, 0, -1
    s_waitcnt vmcnt(0)
    s_barrier
    ds_read_b64_tr_b16 v[16:17], v123 offset:0
    ds_read_b64_tr_b16 v[18:19], v123 offset:1344
    ds_read_b64_tr_b16 v[20:21], v124 offset:0
    ds_read_b64_tr_b16 v[22:23], v124 offset:1344
    ds_read_b64_tr_b16 v[24:25], v125 offset:0
    ds_read_b64_tr_b16 v[26:27], v125 offset:1344
    ds_read_b64_tr_b16 v[28:29], v123 offset:10752
    ds_read_b64_tr_b16 v[30:31], v123 offset:12096
    ds_read_b64_tr_b16 v[32:33], v124 offset:10752
    ds_read_b64_tr_b16 v[34:35], v124 offset:12096
    ds_read_b64_tr_b16 v[36:37], v125 offset:10752
    ds_read_b64_tr_b16 v[38:39], v125 offset:12096
    s_waitcnt lgkmcnt(0)
    s_add_u32 s10, s70, 0
    buffer_store_dwordx4 v[16:19], v5, s[60:63], s10 offen offset:0 sc1
    v_and_b32 v20, v126, v20
    v_and_b32 v21, v126, v21
    v_and_b32 v22, v126, v22
    v_and_b32 v23, v126, v23
    s_add_u32 s10, s70, 14336
    buffer_store_dwordx4 v[20:23], v5, s[60:63], s10 offen offset:0 sc1
    v_and_b32 v24, v127, v24
    v_and_b32 v25, v127, v25
    v_and_b32 v26, v127, v26
    v_and_b32 v27, v127, v27
    s_add_u32 s10, s70, 28672
    buffer_store_dwordx4 v[24:27], v5, s[60:63], s10 offen offset:0 sc1
    s_add_u32 s10, s71, 0
    buffer_store_dwordx4 v[28:31], v5, s[60:63], s10 offen offset:1024 sc1
    v_and_b32 v32, v126, v32
    v_and_b32 v33, v126, v33
    v_and_b32 v34, v126, v34
    v_and_b32 v35, v126, v35
    s_add_u32 s10, s71, 14336
    buffer_store_dwordx4 v[32:35], v5, s[60:63], s10 offen offset:1024 sc1
    v_and_b32 v36, v127, v36
    v_and_b32 v37, v127, v37
    v_and_b32 v38, v127, v38
    v_and_b32 v39, v127, v39
    s_add_u32 s10, s71, 28672
    buffer_store_dwordx4 v[36:39], v5, s[60:63], s10 offen offset:1024 sc1
    s_cmp_lg_u32 s3, 0
    s_nop 0
    s_cbranch_scc1 m_tk7
    s_mov_b32 s40, s36
    s_mov_b32 s41, s37
    s_mov_b32 s42, 256
    s_mov_b32 s43, 0x00020000
    v_mov_b32 v8, 0
    s_mov_b32 s11, 0
    s_nop 0
m_tl7:
    buffer_load_dwordx2 v[10:11], v8, s[40:43], 0 offen sc1
    s_waitcnt vmcnt(0)
m_tc7:
    v_readfirstlane_b32 s56, v10
    v_readfirstlane_b32 s57, v11
    s_add_u32 s11, s11, 1
    s_cmp_gt_u32 s11, 400000
    s_nop 2
    s_cbranch_scc1 m_td7
    s_cmp_eq_u32 s56, 0
    s_cbranch_scc1 m_tl7
    s_cmp_eq_u32 s57, 0
    s_cbranch_scc1 m_tl7
m_td7:
    s_getreg_b32 s10, hwreg(HW_REG_XCC_ID, 0, 4)
    s_or_b32 s57, s57, s10
m_tk7:
    s_lshl_b32 s12, s64, 2
    s_add_u32 s12, s12, s65
    s_waitcnt vmcnt(0)
    s_barrier
    s_cmp_lg_u32 s3, 0
    s_cbranch_scc1 m_sig8
    s_lshl_b32 s10, s12, 7
    s_add_u32 s10, s10, 9469952
    v_mov_b32 v10, 0
    v_mov_b32 v8, s56
    v_mov_b32 v9, s57
    s_mov_b64 exec, 1
    buffer_store_dwordx2 v[8:9], v10, s[60:63], s10 offen sc1
    s_mov_b64 exec, -1
m_sig8:
    s_cmp_lg_u32 s3, 0
    s_cbranch_scc1 m_sig9
    s_lshl_b32 s10, s2, 7
    s_add_u32 s10, s10, 9502720
    v_mov_b32 v10, 0
    v_mov_b32 v8, s56
    v_mov_b32 v9, s57
    s_mov_b64 exec, 1
    buffer_store_dwordx2 v[8:9], v10, s[60:63], s10 offen sc1
    s_mov_b64 exec, -1
m_sig9:
    s_cmp_lg_u32 s3, 6
    s_cbranch_scc1 m_tn10
    s_sub_u32 s10, s2, 224
    v_lshlrev_b32 v112, 7, v2
    s_cmp_eq_u32 s3, 6
    s_nop 0
    s_cbranch_scc1 m_to10
    s_mov_b32 s48, s30
    s_mov_b32 s49, s31
    s_mov_b32 s50, 1204224
    s_mov_b32 s51, 0x00020000
    s_mul_i32 s10, s10, 37632
    buffer_load_dword v113, v112, s[48:51], s10 offen
    s_add_u32 s10, s10, 8192
    buffer_load_dword v114, v112, s[48:51], s10 offen
    s_add_u32 s10, s10, 8192
    buffer_load_dword v115, v112, s[48:51], s10 offen
    s_add_u32 s10, s10, 8192
    buffer_load_dword v116, v112, s[48:51], s10 offen
    s_add_u32 s10, s10, 8192
    buffer_load_dword v117, v112, s[48:51], s10 offen
    s_add_u32 s10, s10, 8192
    s_branch m_tn10
m_to10:
    s_mov_b32 s48, s32
    s_mov_b32 s49, s33
    s_mov_b32 s50, 401408
    s_mov_b32 s51, 0x00020000
    s_mul_i32 s10, s10, 12544
    buffer_load_dword v113, v112, s[48:51], s10 offen
    s_add_u32 s10, s10, 8192
    buffer_load_dword v114, v112, s[48:51], s10 offen
    s_add_u32 s10, s10, 8192
m_tn10:
    s_mov_b32 s52, s16
    s_mov_b32 s53, s17
    s_mov_b32 s54, 1835008
    s_mov_b32 s55, 0x00020000
    s_mul_i32 s10, s4, 57344
    s_mul_i32 s11, s3, 7168
    s_add_u32 s10, s10, s11
    s_mul_i32 s11, s6, 14336
    s_add_u32 s11, s11, 101376
    s_cmp_eq_u32 s6, 0
    s_cselect_b32 s11, 51840, s11
    s_mul_i32 s12, s7, 7168
    s_add_u32 s11, s11, s12
    s_mov_b32 m0, s11
    s_nop 0
    buffer_load_dwordx4 v5, s[52:55], s10 offen offset:0 lds
    buffer_load_dwordx4 v5, s[52:55], s10 offen offset:1024 lds
    buffer_load_dwordx4 v5, s[52:55], s10 offen offset:2048 lds
    buffer_load_dwordx4 v5, s[52:55], s10 offen offset:3072 lds
    s_add_u32 s10, s10, 4096
    s_add_u32 s11, s11, 4096
    s_mov_b32 m0, s11
    s_nop 0
    buffer_load_dwordx4 v5, s[52:55], s10 offen offset:0 lds
    buffer_load_dwordx4 v5, s[52:55], s10 offen offset:1024 lds
    buffer_load_dwordx4 v5, s[52:55], s10 offen offset:2048 lds
    s_cmp_lg_u32 s3, 0
    s_cbranch_scc1 m_wd11
    s_lshl_b32 s10, s5, 2
    v_add_u32 v8, 0, v2
    v_min_u32 v8, 3, v8
    v_add_u32 v8, s10, v8
    v_max_i32 v8, 0, v8
    v_lshlrev_b32 v8, 7, v8
    s_mov_b32 s10, 9469952
    s_mov_b32 s11, 0
    buffer_load_dwordx2 v[96:97], v8, s[60:63], s10 offen sc1
    s_sleep 2
m_wl11:
    buffer_load_dwordx2 v[100:101], v8, s[60:63], s10 offen sc1
    s_waitcnt vmcnt(1)
    v_xor_b32 v96, s56, v96
    v_xor_b32 v97, s57, v97
    v_lshrrev_b32 v98, 8, v97
    v_or_b32 v98, v98, v96
    v_cmp_ne_u32 vcc, 0, v98
    s_nop 4
    s_cbranch_vccz m_wa11
    buffer_load_dwordx2 v[96:97], v8, s[60:63], s10 offen sc1
    s_waitcnt vmcnt(1)
    v_xor_b32 v100, s56, v100
    v_xor_b32 v101, s57, v101
    v_lshrrev_b32 v102, 8, v101
    v_or_b32 v102, v102, v100
    v_cmp_ne_u32 vcc, 0, v102
    s_nop 4
    s_cbranch_vccz m_wb11
    s_add_u32 s11, s11, 1
    s_cmp_gt_u32 s11, 200000
    s_cbranch_scc0 m_wl11
    s_branch m_wb11
m_wa11:
m_wb11:
m_wd11:
    s_barrier
    s_mul_i32 s71, s7, 7168
    s_lshl_b32 s72, s5, 2
    s_add_u32 s72, s72, s6
    s_mul_i32 s70, s72, 24576
    s_add_u32 s70, s70, 8388608
    s_mul_i32 s72, s72, 43008
    s_add_u32 s72, s72, s71
    s_add_u32 s72, s72, 6291456
    s_add_u32 s73, s72, 14336
    s_add_u32 s74, s72, 28672
    s_waitcnt vmcnt(0)
    s_barrier
m_nop1b:
    v_mul_u32_u24 v8, 896, v3
    s_mul_i32 s10, s6, 14336
    s_add_u32 s10, s10, 101376
    s_cmp_eq_u32 s6, 0
    s_cselect_b32 s10, 51840, s10
    s_mul_i32 s11, s7, 448
    s_add_u32 s10, s10, s11
    v_lshl_add_u32 v8, v4, 4, v8
    v_add_u32 v8, s10, v8
    ds_read_b128 a[84:87], v8 offset:0
    ds_read_b128 a[88:91], v8 offset:64
    ds_read_b128 a[92:95], v8 offset:128
    ds_read_b128 a[96:99], v8 offset:192
    ds_read_b128 a[100:103], v8 offset:256
    ds_read_b128 a[104:107], v8 offset:320
    ds_read_b128 a[108:111], v8 offset:384
    v_mov_b32 v72, s78
    v_mov_b32 v73, s78
    v_mov_b32 v74, s78
    v_mov_b32 v75, s78
    s_lshl_b32 s10, s3, 10
    s_add_u32 s10, s10, 139264
    v_add_u32 v14, s10, v5
    v_lshrrev_b32 v11, 2, v3
    v_lshl_add_u32 v11, v11, 4, v3
    v_lshlrev_b32 v11, 4, v11
    v_and_b32 v12, 3, v3
    v_lshl_add_u32 v11, v12, 2, v11
    v_add_u32 v11, s10, v11
    v_xor_b32 v12, 1024, v11
    s_lshl_b32 s10, s3, 8
    s_add_u32 s10, s10, 147456
    v_lshl_add_u32 v15, v3, 2, s10
    v_xor_b32 v13, 256, v15
    s_cmp_eq_u32 s3, 0
    s_nop 0
    s_cbranch_scc1 m_p2w0
    buffer_load_dwordx4 a[0:3], v5, s[60:63], s72 offen offset:0 sc1
    buffer_load_dwordx4 a[4:7], v5, s[60:63], s73 offen offset:0 sc1
    s_waitcnt lgkmcnt(0)
    s_barrier
    v_mfma_f32_16x16x32_bf16 v[76:79], v[72:75], a[84:87], 0
    v_mfma_f32_16x16x32_bf16 v[80:83], a[84:87], a[84:87], 0
    v_mfma_f32_16x16x32_bf16 v[76:79], v[72:75], a[88:91], v[76:79]
    v_mfma_f32_16x16x32_bf16 v[80:83], a[88:91], a[88:91], v[80:83]
    v_mfma_f32_16x16x32_bf16 v[76:79], v[72:75], a[92:95], v[76:79]
    v_mfma_f32_16x16x32_bf16 v[80:83], a[92:95], a[92:95], v[80:83]
    v_mfma_f32_16x16x32_bf16 v[76:79], v[72:75], a[96:99], v[76:79]
    v_mfma_f32_16x16x32_bf16 v[80:83], a[96:99], a[96:99], v[80:83]
    v_mfma_f32_16x16x32_bf16 v[76:79], v[72:75], a[100:103], v[76:79]
    v_mfma_f32_16x16x32_bf16 v[80:83], a[100:103], a[100:103], v[80:83]
    v_mfma_f32_16x16x32_bf16 v[76:79], v[72:75], a[104:107], v[76:79]
    v_mfma_f32_16x16x32_bf16 v[80:83], a[104:107], a[104:107], v[80:83]
    v_mfma_f32_16x16x32_bf16 v[76:79], v[72:75], a[108:111], v[76:79]
    v_mfma_f32_16x16x32_bf16 v[80:83], a[108:111], a[108:111], v[80:83]
    buffer_load_dwordx4 a[8:11], v5, s[60:63], s74 offen offset:0 sc1
    buffer_load_dwordx4 a[12:15], v5, s[60:63], s72 offen offset:1024 sc1
    v_accvgpr_read_b32 v88, a84
    v_accvgpr_read_b32 v89, a85
    v_accvgpr_read_b32 v90, a86
    v_accvgpr_read_b32 v91, a87
    v_lshlrev_b32 v16, 16, v88
    v_and_b32 v17, 0xffff0000, v88
    v_lshlrev_b32 v18, 16, v89
    v_and_b32 v19, 0xffff0000, v89
    v_lshlrev_b32 v20, 16, v90
    v_and_b32 v21, 0xffff0000, v90
    v_lshlrev_b32 v22, 16, v91
    v_and_b32 v23, 0xffff0000, v91
    buffer_load_dwordx4 a[16:19], v5, s[60:63], s73 offen offset:1024 sc1
    buffer_load_dwordx4 a[20:23], v5, s[60:63], s74 offen offset:1024 sc1
    v_accvgpr_read_b32 v88, a88
    v_accvgpr_read_b32 v89, a89
    v_accvgpr_read_b32 v90, a90
    v_accvgpr_read_b32 v91, a91
    v_lshlrev_b32 v24, 16, v88
    v_and_b32 v25, 0xffff0000, v88
    v_lshlrev_b32 v26, 16, v89
    v_and_b32 v27, 0xffff0000, v89
    v_lshlrev_b32 v28, 16, v90
    v_and_b32 v29, 0xffff0000, v90
    v_lshlrev_b32 v30, 16, v91
    v_and_b32 v31, 0xffff0000, v91
    buffer_load_dwordx4 a[24:27], v5, s[60:63], s72 offen offset:2048 sc1
    buffer_load_dwordx4 a[28:31], v5, s[60:63], s73 offen offset:2048 sc1
    v_accvgpr_read_b32 v88, a92
    v_accvgpr_read_b32 v89, a93
    v_accvgpr_read_b32 v90, a94
    v_accvgpr_read_b32 v91, a95
    v_lshlrev_b32 v32, 16, v88
    v_and_b32 v33, 0xffff0000, v88
    v_lshlrev_b32 v34, 16, v89
    v_and_b32 v35, 0xffff0000, v89
    v_lshlrev_b32 v36, 16, v90
    v_and_b32 v37, 0xffff0000, v90
    v_lshlrev_b32 v38, 16, v91
    v_and_b32 v39, 0xffff0000, v91
    buffer_load_dwordx4 a[32:35], v5, s[60:63], s74 offen offset:2048 sc1
    buffer_load_dwordx4 a[36:39], v5, s[60:63], s72 offen offset:3072 sc1
    v_accvgpr_read_b32 v88, a96
    v_accvgpr_read_b32 v89, a97
    v_accvgpr_read_b32 v90, a98
    v_accvgpr_read_b32 v91, a99
    v_lshlrev_b32 v40, 16, v88
    v_and_b32 v41, 0xffff0000, v88
    v_lshlrev_b32 v42, 16, v89
    v_and_b32 v43, 0xffff0000, v89
    v_lshlrev_b32 v44, 16, v90
    v_and_b32 v45, 0xffff0000, v90
    v_lshlrev_b32 v46, 16, v91
    v_and_b32 v47, 0xffff0000, v91
    buffer_load_dwordx4 a[40:43], v5, s[60:63], s73 offen offset:3072 sc1
    buffer_load_dwordx4 a[44:47], v5, s[60:63], s74 offen offset:3072 sc1
    v_accvgpr_read_b32 v88, a100
    v_accvgpr_read_b32 v89, a101
    v_accvgpr_read_b32 v90, a102
    v_accvgpr_read_b32 v91, a103
    v_lshlrev_b32 v48, 16, v88
    v_and_b32 v49, 0xffff0000, v88
    v_lshlrev_b32 v50, 16, v89
    v_and_b32 v51, 0xffff0000, v89
    v_lshlrev_b32 v52, 16, v90
    v_and_b32 v53, 0xffff0000, v90
    v_lshlrev_b32 v54, 16, v91
    v_and_b32 v55, 0xffff0000, v91
    v_accvgpr_read_b32 v88, a104
    v_accvgpr_read_b32 v89, a105
    v_accvgpr_read_b32 v90, a106
    v_accvgpr_read_b32 v91, a107
    v_lshlrev_b32 v56, 16, v88
    v_and_b32 v57, 0xffff0000, v88
    v_lshlrev_b32 v58, 16, v89
    v_and_b32 v59, 0xffff0000, v89
    v_lshlrev_b32 v60, 16, v90
    v_and_b32 v61, 0xffff0000, v90
    v_lshlrev_b32 v62, 16, v91
    v_and_b32 v63, 0xffff0000, v91
    v_accvgpr_read_b32 v88, a108
    v_accvgpr_read_b32 v89, a109
    v_accvgpr_read_b32 v90, a110
    v_accvgpr_read_b32 v91, a111
    v_lshlrev_b32 v64, 16, v88
    v_and_b32 v65, 0xffff0000, v88
    v_lshlrev_b32 v66, 16, v89
    v_and_b32 v67, 0xffff0000, v89
    v_lshlrev_b32 v68, 16, v90
    v_and_b32 v69, 0xffff0000, v90
    v_lshlrev_b32 v70, 16, v91
    v_and_b32 v71, 0xffff0000, v91
    s_nop 1
    s_branch m_p2w1
m_p2w0:
    buffer_load_dwordx4 a[0:3], v5, s[60:63], s72 offen offset:0 sc1
    buffer_load_dwordx4 a[4:7], v5, s[60:63], s73 offen offset:0 sc1
    buffer_load_dwordx4 a[8:11], v5, s[60:63], s74 offen offset:0 sc1
    buffer_load_dwordx4 a[12:15], v5, s[60:63], s72 offen offset:1024 sc1
    buffer_load_dwordx4 a[16:19], v5, s[60:63], s73 offen offset:1024 sc1
    buffer_load_dwordx4 a[20:23], v5, s[60:63], s74 offen offset:1024 sc1
    buffer_load_dwordx4 a[24:27], v5, s[60:63], s72 offen offset:2048 sc1
    buffer_load_dwordx4 a[28:31], v5, s[60:63], s73 offen offset:2048 sc1
    buffer_load_dwordx4 a[32:35], v5, s[60:63], s74 offen offset:2048 sc1
    buffer_load_dwordx4 a[36:39], v5, s[60:63], s72 offen offset:3072 sc1
    buffer_load_dwordx4 a[40:43], v5, s[60:63], s73 offen offset:3072 sc1
    buffer_load_dwordx4 a[44:47], v5, s[60:63], s74 offen offset:3072 sc1
    s_waitcnt lgkmcnt(0)
    s_barrier
    v_mfma_f32_16x16x32_bf16 v[76:79], v[72:75], a[84:87], 0
    v_mfma_f32_16x16x32_bf16 v[80:83], a[84:87], a[84:87], 0
    v_mfma_f32_16x16x32_bf16 v[76:79], v[72:75], a[88:91], v[76:79]
    v_mfma_f32_16x16x32_bf16 v[80:83], a[88:91], a[88:91], v[80:83]
    v_mfma_f32_16x16x32_bf16 v[76:79], v[72:75], a[92:95], v[76:79]
    v_mfma_f32_16x16x32_bf16 v[80:83], a[92:95], a[92:95], v[80:83]
    v_mfma_f32_16x16x32_bf16 v[76:79], v[72:75], a[96:99], v[76:79]
    v_mfma_f32_16x16x32_bf16 v[80:83], a[96:99], a[96:99], v[80:83]
    v_mfma_f32_16x16x32_bf16 v[76:79], v[72:75], a[100:103], v[76:79]
    v_mfma_f32_16x16x32_bf16 v[80:83], a[100:103], a[100:103], v[80:83]
    v_mfma_f32_16x16x32_bf16 v[76:79], v[72:75], a[104:107], v[76:79]
    v_mfma_f32_16x16x32_bf16 v[80:83], a[104:107], a[104:107], v[80:83]
    v_mfma_f32_16x16x32_bf16 v[76:79], v[72:75], a[108:111], v[76:79]
    v_mfma_f32_16x16x32_bf16 v[80:83], a[108:111], a[108:111], v[80:83]
    v_accvgpr_read_b32 v88, a84
    v_accvgpr_read_b32 v89, a85
    v_accvgpr_read_b32 v90, a86
    v_accvgpr_read_b32 v91, a87
    v_lshlrev_b32 v16, 16, v88
    v_and_b32 v17, 0xffff0000, v88
    v_lshlrev_b32 v18, 16, v89
    v_and_b32 v19, 0xffff0000, v89
    v_lshlrev_b32 v20, 16, v90
    v_and_b32 v21, 0xffff0000, v90
    v_lshlrev_b32 v22, 16, v91
    v_and_b32 v23, 0xffff0000, v91
    v_accvgpr_read_b32 v88, a88
    v_accvgpr_read_b32 v89, a89
    v_accvgpr_read_b32 v90, a90
    v_accvgpr_read_b32 v91, a91
    v_lshlrev_b32 v24, 16, v88
    v_and_b32 v25, 0xffff0000, v88
    v_lshlrev_b32 v26, 16, v89
    v_and_b32 v27, 0xffff0000, v89
    v_lshlrev_b32 v28, 16, v90
    v_and_b32 v29, 0xffff0000, v90
    v_lshlrev_b32 v30, 16, v91
    v_and_b32 v31, 0xffff0000, v91
    v_accvgpr_read_b32 v88, a92
    v_accvgpr_read_b32 v89, a93
    v_accvgpr_read_b32 v90, a94
    v_accvgpr_read_b32 v91, a95
    v_lshlrev_b32 v32, 16, v88
    v_and_b32 v33, 0xffff0000, v88
    v_lshlrev_b32 v34, 16, v89
    v_and_b32 v35, 0xffff0000, v89
    v_lshlrev_b32 v36, 16, v90
    v_and_b32 v37, 0xffff0000, v90
    v_lshlrev_b32 v38, 16, v91
    v_and_b32 v39, 0xffff0000, v91
    v_accvgpr_read_b32 v88, a96
    v_accvgpr_read_b32 v89, a97
    v_accvgpr_read_b32 v90, a98
    v_accvgpr_read_b32 v91, a99
    v_lshlrev_b32 v40, 16, v88
    v_and_b32 v41, 0xffff0000, v88
    v_lshlrev_b32 v42, 16, v89
    v_and_b32 v43, 0xffff0000, v89
    v_lshlrev_b32 v44, 16, v90
    v_and_b32 v45, 0xffff0000, v90
    v_lshlrev_b32 v46, 16, v91
    v_and_b32 v47, 0xffff0000, v91
    v_accvgpr_read_b32 v88, a100
    v_accvgpr_read_b32 v89, a101
    v_accvgpr_read_b32 v90, a102
    v_accvgpr_read_b32 v91, a103
    v_lshlrev_b32 v48, 16, v88
    v_and_b32 v49, 0xffff0000, v88
    v_lshlrev_b32 v50, 16, v89
    v_and_b32 v51, 0xffff0000, v89
    v_lshlrev_b32 v52, 16, v90
    v_and_b32 v53, 0xffff0000, v90
    v_lshlrev_b32 v54, 16, v91
    v_and_b32 v55, 0xffff0000, v91
    v_accvgpr_read_b32 v88, a104
    v_accvgpr_read_b32 v89, a105
    v_accvgpr_read_b32 v90, a106
    v_accvgpr_read_b32 v91, a107
    v_lshlrev_b32 v56, 16, v88
    v_and_b32 v57, 0xffff0000, v88
    v_lshlrev_b32 v58, 16, v89
    v_and_b32 v59, 0xffff0000, v89
    v_lshlrev_b32 v60, 16, v90
    v_and_b32 v61, 0xffff0000, v90
    v_lshlrev_b32 v62, 16, v91
    v_and_b32 v63, 0xffff0000, v91
    v_accvgpr_read_b32 v88, a108
    v_accvgpr_read_b32 v89, a109
    v_accvgpr_read_b32 v90, a110
    v_accvgpr_read_b32 v91, a111
    v_lshlrev_b32 v64, 16, v88
    v_and_b32 v65, 0xffff0000, v88
    v_lshlrev_b32 v66, 16, v89
    v_and_b32 v67, 0xffff0000, v89
    v_lshlrev_b32 v68, 16, v90
    v_and_b32 v69, 0xffff0000, v90
    v_lshlrev_b32 v70, 16, v91
    v_and_b32 v71, 0xffff0000, v91
    s_nop 1
m_p2w1:
    ds_write_b128 v14, v[80:83] offset:0
    ds_write_b32 v15, v76 offset:0
    v_bfe_u32 v112, v2, 1, 2
    v_bfe_u32 v113, v2, 4, 1
    v_xor_b32 v112, v112, v113
    v_and_b32 v113, 1, v2
    v_lshl_add_u32 v112, v112, 1, v113
    s_lshl_b32 s11, s7, 2
    v_xor_b32 v112, s11, v112
    v_lshlrev_b32 v112, 4, v112
    v_xor_b32 v113, 64, v112
    v_lshrrev_b32 v114, 3, v2
    s_movk_i32 s11, 4224
    v_mul_lo_u32 v114, v114, s11
    s_lshl_b32 s11, s4, 7
    v_add3_u32 v112, v112, v114, s11
    v_add3_u32 v113, v113, v114, s11
    s_mul_i32 s12, s3, 7
    s_mul_i32 s64, s12, 33792
    s_add_u32 s64, s64, 4194304
    s_lshl_b32 s65, s12, 10
    s_add_u32 s65, s65, 65536
    s_cmp_lg_u32 s3, 0
    s_cbranch_scc1 m_wd12
    s_mov_b32 s10, 0
    v_add_u32 v8, 0, v2
    v_min_u32 v8, 255, v8
    v_add_u32 v8, s10, v8
    v_max_i32 v8, 0, v8
    v_lshlrev_b32 v8, 7, v8
    v_add_u32 v9, 64, v2
    v_min_u32 v9, 255, v9
    v_add_u32 v9, s10, v9
    v_max_i32 v9, 0, v9
    v_lshlrev_b32 v9, 7, v9
    v_add_u32 v10, 128, v2
    v_min_u32 v10, 255, v10
    v_add_u32 v10, s10, v10
    v_max_i32 v10, 0, v10
    v_lshlrev_b32 v10, 7, v10
    v_add_u32 v11, 192, v2
    v_min_u32 v11, 255, v11
    v_add_u32 v11, s10, v11
    v_max_i32 v11, 0, v11
    v_lshlrev_b32 v11, 7, v11
    s_mov_b32 s10, 9502720
    s_mov_b32 s11, 0
    buffer_load_dwordx2 v[96:97], v8, s[60:63], s10 offen sc1
    buffer_load_dwordx2 v[98:99], v9, s[60:63], s10 offen sc1
    buffer_load_dwordx2 v[100:101], v10, s[60:63], s10 offen sc1
    buffer_load_dwordx2 v[102:103], v11, s[60:63], s10 offen sc1
    s_sleep 2
m_wl12:
    buffer_load_dwordx2 v[104:105], v8, s[60:63], s10 offen sc1
    buffer_load_dwordx2 v[106:107], v9, s[60:63], s10 offen sc1
    buffer_load_dwordx2 v[108:109], v10, s[60:63], s10 offen sc1
    buffer_load_dwordx2 v[110:111], v11, s[60:63], s10 offen sc1
    s_waitcnt vmcnt(4)
    v_xor_b32 v96, s56, v96
    v_xor_b32 v97, s57, v97
    v_xor_b32 v98, s56, v98
    v_xor_b32 v99, s57, v99
    v_xor_b32 v100, s56, v100
    v_xor_b32 v101, s57, v101
    v_xor_b32 v102, s56, v102
    v_xor_b32 v103, s57, v103
    v_or_b32 v96, v96, v98
    v_or_b32 v97, v97, v99
    v_or_b32 v96, v96, v100
    v_or_b32 v97, v97, v101
    v_or_b32 v96, v96, v102
    v_or_b32 v97, v97, v103
    v_lshrrev_b32 v98, 8, v97
    v_or_b32 v98, v98, v96
    v_cmp_ne_u32 vcc, 0, v98
    s_nop 4
    s_cbranch_vccz m_wa12
    buffer_load_dwordx2 v[96:97], v8, s[60:63], s10 offen sc1
    buffer_load_dwordx2 v[98:99], v9, s[60:63], s10 offen sc1
    buffer_load_dwordx2 v[100:101], v10, s[60:63], s10 offen sc1
    buffer_load_dwordx2 v[102:103], v11, s[60:63], s10 offen sc1
    s_waitcnt vmcnt(4)
    v_xor_b32 v104, s56, v104
    v_xor_b32 v105, s57, v105
    v_xor_b32 v106, s56, v106
    v_xor_b32 v107, s57, v107
    v_xor_b32 v108, s56, v108
    v_xor_b32 v109, s57, v109
    v_xor_b32 v110, s56, v110
    v_xor_b32 v111, s57, v111
    v_or_b32 v104, v104, v106
    v_or_b32 v105, v105, v107
    v_or_b32 v104, v104, v108
    v_or_b32 v105, v105, v109
    v_or_b32 v104, v104, v110
    v_or_b32 v105, v105, v111
    v_lshrrev_b32 v106, 8, v105
    v_or_b32 v106, v106, v104
    v_cmp_ne_u32 vcc, 0, v106
    v_mov_b32 v115, v105
    s_nop 3
    s_cbranch_vccz m_wb12
    s_add_u32 s11, s11, 1
    s_cmp_gt_u32 s11, 200000
    s_cbranch_scc0 m_wl12
    s_branch m_wb12
m_wa12:
    v_mov_b32 v115, v97
    s_nop 1
m_wb12:
    v_and_b32 v8, 7, v2
    s_and_b32 s11, s2, 7
    v_cmp_eq_u32 s[12:13], s11, v8
    v_cmp_ne_u32 vcc, 0, v115
    s_nop 1
    s_and_b64 s[12:13], s[12:13], vcc
    s_cmp_eq_u64 s[12:13], 0
    s_cselect_b32 s75, 1, 0
m_wd12:
    s_waitcnt lgkmcnt(0)
    s_barrier
    s_mov_b32 m0, s65
    s_nop 0
    buffer_load_dwordx4 v112, s[60:63], s64 offen sc1 lds
    s_add_u32 s64, s64, 33792
    s_add_u32 s65, s65, 1024
    s_mov_b32 m0, s65
    s_nop 0
    buffer_load_dwordx4 v113, s[60:63], s64 offen sc1 lds
    s_add_u32 s64, s64, 33792
    s_add_u32 s65, s65, 1024
    s_mov_b32 m0, s65
    s_nop 0
    buffer_load_dwordx4 v112, s[60:63], s64 offen sc1 lds
    s_add_u32 s64, s64, 33792
    s_add_u32 s65, s65, 1024
    s_mov_b32 m0, s65
    s_nop 0
    buffer_load_dwordx4 v113, s[60:63], s64 offen sc1 lds
    s_add_u32 s64, s64, 33792
    s_add_u32 s65, s65, 1024
    s_mov_b32 m0, s65
    s_nop 0
    buffer_load_dwordx4 v112, s[60:63], s64 offen sc1 lds
    s_add_u32 s64, s64, 33792
    s_add_u32 s65, s65, 1024
    s_mov_b32 m0, s65
    s_nop 0
    buffer_load_dwordx4 v113, s[60:63], s64 offen sc1 lds
    s_add_u32 s64, s64, 33792
    s_add_u32 s65, s65, 1024
    s_mov_b32 m0, s65
    s_nop 0
    buffer_load_dwordx4 v112, s[60:63], s64 offen sc1 lds
    s_lshl_b32 s10, s3, 10
    s_add_u32 s10, s10, 139264
    v_add_u32 v14, s10, v5
    v_lshrrev_b32 v11, 2, v3
    v_lshl_add_u32 v11, v11, 4, v3
    v_lshlrev_b32 v11, 4, v11
    v_and_b32 v12, 3, v3
    v_lshl_add_u32 v11, v12, 2, v11
    v_add_u32 v11, s10, v11
    v_xor_b32 v12, 1024, v11
    s_lshl_b32 s10, s3, 8
    s_add_u32 s10, s10, 147456
    v_lshl_add_u32 v15, v3, 2, s10
    v_xor_b32 v13, 256, v15
    ds_read_b32 v128, v11 offset:0
    ds_read_b32 v129, v12 offset:0
    ds_read_b32 v130, v13 offset:0
    s_waitcnt lgkmcnt(0)
    v_add_f32 v128, v128, v129
    v_add_f32 v76, v76, v130
    v_mul_f32 v76, s76, v76
    v_mul_f32 v128, s76, v128
    v_fma_f32 v128, -v76, v76, v128
    v_max_f32 v128, 0, v128
    v_cvt_pk_bf16_f32 v129, v76, v128
    v_lshlrev_b32 v76, 16, v129
    v_and_b32 v128, 0xffff0000, v129
    v_add_f32 v128, s77, v128
    v_cvt_pk_bf16_f32 v129, v76, v128
    v_lshlrev_b32 v76, 16, v129
    v_and_b32 v128, 0xffff0000, v129
    v_sqrt_f32 v128, v128
    s_nop 0
    v_cvt_pk_bf16_f32 v129, v76, v128
    v_lshlrev_b32 v76, 16, v129
    v_and_b32 v128, 0xffff0000, v129
    v_rcp_f32 v84, v128
    s_nop 0
    v_mul_f32 v86, -v76, v84
    v_mov_b32 v85, v84
    v_mov_b32 v87, v86
    v_bfe_u32 v10, v2, 2, 2
    v_lshl_add_u32 v9, v4, 3, v10
    v_lshlrev_b32 v9, 7, v9
    v_lshrrev_b32 v10, 1, v10
    v_and_b32 v128, 1, v4
    v_lshl_or_b32 v10, v128, 1, v10
    v_xor_b32 v10, s6, v10
    v_lshl_add_u32 v9, v10, 5, v9
    v_and_b32 v10, 3, v2
    v_lshl_add_u32 v9, v10, 3, v9
    s_mul_i32 s10, s7, 28672
    s_add_u32 s10, s10, 65536
    v_add_u32 v9, s10, v9
    s_mul_i32 s10, s6, 14336
    s_mul_i32 s11, s7, 7168
    s_add_u32 s10, s10, s11
    v_add_u32 v10, s10, v5
    s_waitcnt vmcnt(7)
    v_mfma_f32_16x16x32_bf16 a[112:115], a[0:3], v[72:75], 0
    v_mfma_f32_16x16x32_bf16 a[116:119], a[4:7], v[72:75], 0
    v_mfma_f32_16x16x32_bf16 a[120:123], v[72:75], a[8:11], 0
    v_mfma_f32_16x16x32_bf16 a[112:115], a[12:15], v[72:75], a[112:115]
    v_mfma_f32_16x16x32_bf16 a[116:119], a[16:19], v[72:75], a[116:119]
    v_mfma_f32_16x16x32_bf16 a[120:123], v[72:75], a[20:23], a[120:123]
    v_mfma_f32_16x16x32_bf16 a[112:115], a[24:27], v[72:75], a[112:115]
    v_mfma_f32_16x16x32_bf16 a[116:119], a[28:31], v[72:75], a[116:119]
    v_mfma_f32_16x16x32_bf16 a[120:123], v[72:75], a[32:35], a[120:123]
    v_mfma_f32_16x16x32_bf16 a[112:115], a[36:39], v[72:75], a[112:115]
    v_mfma_f32_16x16x32_bf16 a[116:119], a[40:43], v[72:75], a[116:119]
    v_mfma_f32_16x16x32_bf16 a[120:123], v[72:75], a[44:47], a[120:123]
    s_waitcnt vmcnt(0)
    s_barrier
    ds_read_b64_tr_b16 v[96:97], v9 offset:0
    ds_read_b64_tr_b16 v[98:99], v9 offset:512
    ds_read_b64_tr_b16 v[100:101], v9 offset:4096
    ds_read_b64_tr_b16 v[102:103], v9 offset:4608
    ds_read_b64_tr_b16 v[104:105], v9 offset:8192
    ds_read_b64_tr_b16 v[106:107], v9 offset:8704
    ds_read_b64_tr_b16 v[108:109], v9 offset:12288
    ds_read_b64_tr_b16 v[110:111], v9 offset:12800
    ds_read_b64_tr_b16 v[112:113], v9 offset:16384
    ds_read_b64_tr_b16 v[114:115], v9 offset:16896
    ds_read_b64_tr_b16 v[116:117], v9 offset:20480
    ds_read_b64_tr_b16 v[118:119], v9 offset:20992
    ds_read_b64_tr_b16 v[120:121], v9 offset:24576
    ds_read_b64_tr_b16 v[122:123], v9 offset:25088
    s_waitcnt lgkmcnt(12)
    v_lshlrev_b32 v88, 16, v96
    v_and_b32 v89, 0xffff0000, v96
    v_lshlrev_b32 v90, 16, v97
    v_and_b32 v91, 0xffff0000, v97
    v_lshlrev_b32 v92, 16, v98
    v_and_b32 v93, 0xffff0000, v98
    v_lshlrev_b32 v94, 16, v99
    v_and_b32 v95, 0xffff0000, v99
    v_pk_fma_f32 v[124:125], v[16:17], v[84:85], v[86:87]
    v_pk_fma_f32 v[126:127], v[18:19], v[84:85], v[86:87]
    v_pk_fma_f32 v[128:129], v[20:21], v[84:85], v[86:87]
    v_pk_fma_f32 v[130:131], v[22:23], v[84:85], v[86:87]
    v_pk_fma_f32 v[124:125], v[124:125], v[88:89], v[16:17]
    v_pk_fma_f32 v[126:127], v[126:127], v[90:91], v[18:19]
    v_pk_fma_f32 v[128:129], v[128:129], v[92:93], v[20:21]
    v_pk_fma_f32 v[130:131], v[130:131], v[94:95], v[22:23]
    v_cvt_pk_bf16_f32 v96, v124, v125
    v_cvt_pk_bf16_f32 v97, v126, v127
    v_cvt_pk_bf16_f32 v98, v128, v129
    v_cvt_pk_bf16_f32 v99, v130, v131
    ds_write_b128 v10, v[96:99] offset:0
    s_nop 0
    v_mfma_f32_16x16x32_bf16 v[76:79], v[72:75], v[96:99], 0
    v_mfma_f32_16x16x32_bf16 v[80:83], v[96:99], v[96:99], 0
    ds_read_b64_tr_b16 a[84:85], v9 offset:0
    ds_read_b64_tr_b16 a[86:87], v9 offset:512
    buffer_load_dwordx4 a[48:51], v7, s[60:63], s72 offen offset:0 sc1
    buffer_load_dwordx4 a[52:55], v7, s[60:63], s73 offen offset:0 sc1
    s_waitcnt lgkmcnt(13)
    v_lshlrev_b32 v88, 16, v100
    v_and_b32 v89, 0xffff0000, v100
    v_lshlrev_b32 v90, 16, v101
    v_and_b32 v91, 0xffff0000, v101
    v_lshlrev_b32 v92, 16, v102
    v_and_b32 v93, 0xffff0000, v102
    v_lshlrev_b32 v94, 16, v103
    v_and_b32 v95, 0xffff0000, v103
    v_pk_fma_f32 v[124:125], v[24:25], v[84:85], v[86:87]
    v_pk_fma_f32 v[126:127], v[26:27], v[84:85], v[86:87]
    v_pk_fma_f32 v[128:129], v[28:29], v[84:85], v[86:87]
    v_pk_fma_f32 v[130:131], v[30:31], v[84:85], v[86:87]
    v_pk_fma_f32 v[124:125], v[124:125], v[88:89], v[24:25]
    v_pk_fma_f32 v[126:127], v[126:127], v[90:91], v[26:27]
    v_pk_fma_f32 v[128:129], v[128:129], v[92:93], v[28:29]
    v_pk_fma_f32 v[130:131], v[130:131], v[94:95], v[30:31]
    v_cvt_pk_bf16_f32 v100, v124, v125
    v_cvt_pk_bf16_f32 v101, v126, v127
    v_cvt_pk_bf16_f32 v102, v128, v129
    v_cvt_pk_bf16_f32 v103, v130, v131
    ds_write_b128 v10, v[100:103] offset:1024
    s_nop 0
    v_mfma_f32_16x16x32_bf16 v[76:79], v[72:75], v[100:103], v[76:79]
    v_mfma_f32_16x16x32_bf16 v[80:83], v[100:103], v[100:103], v[80:83]
    ds_read_b64_tr_b16 a[88:89], v9 offset:4096
    ds_read_b64_tr_b16 a[90:91], v9 offset:4608
    buffer_load_dwordx4 a[56:59], v7, s[60:63], s74 offen offset:0 sc1
    buffer_load_dwordx4 a[60:63], v7, s[60:63], s72 offen offset:1024 sc1
    s_waitcnt lgkmcnt(14)
    v_lshlrev_b32 v88, 16, v104
    v_and_b32 v89, 0xffff0000, v104
    v_lshlrev_b32 v90, 16, v105
    v_and_b32 v91, 0xffff0000, v105
    v_lshlrev_b32 v92, 16, v106
    v_and_b32 v93, 0xffff0000, v106
    v_lshlrev_b32 v94, 16, v107
    v_and_b32 v95, 0xffff0000, v107
    v_pk_fma_f32 v[124:125], v[32:33], v[84:85], v[86:87]
    v_pk_fma_f32 v[126:127], v[34:35], v[84:85], v[86:87]
    v_pk_fma_f32 v[128:129], v[36:37], v[84:85], v[86:87]
    v_pk_fma_f32 v[130:131], v[38:39], v[84:85], v[86:87]
    v_pk_fma_f32 v[124:125], v[124:125], v[88:89], v[32:33]
    v_pk_fma_f32 v[126:127], v[126:127], v[90:91], v[34:35]
    v_pk_fma_f32 v[128:129], v[128:129], v[92:93], v[36:37]
    v_pk_fma_f32 v[130:131], v[130:131], v[94:95], v[38:39]
    v_cvt_pk_bf16_f32 v104, v124, v125
    v_cvt_pk_bf16_f32 v105, v126, v127
    v_cvt_pk_bf16_f32 v106, v128, v129
    v_cvt_pk_bf16_f32 v107, v130, v131
    ds_write_b128 v10, v[104:107] offset:2048
    s_nop 0
    v_mfma_f32_16x16x32_bf16 v[76:79], v[72:75], v[104:107], v[76:79]
    v_mfma_f32_16x16x32_bf16 v[80:83], v[104:107], v[104:107], v[80:83]
    ds_read_b64_tr_b16 a[92:93], v9 offset:8192
    ds_read_b64_tr_b16 a[94:95], v9 offset:8704
    buffer_load_dwordx4 a[64:67], v7, s[60:63], s73 offen offset:1024 sc1
    buffer_load_dwordx4 a[68:71], v7, s[60:63], s74 offen offset:1024 sc1
    s_waitcnt lgkmcnt(15)
    v_lshlrev_b32 v88, 16, v108
    v_and_b32 v89, 0xffff0000, v108
    v_lshlrev_b32 v90, 16, v109
    v_and_b32 v91, 0xffff0000, v109
    v_lshlrev_b32 v92, 16, v110
    v_and_b32 v93, 0xffff0000, v110
    v_lshlrev_b32 v94, 16, v111
    v_and_b32 v95, 0xffff0000, v111
    v_pk_fma_f32 v[124:125], v[40:41], v[84:85], v[86:87]
    v_pk_fma_f32 v[126:127], v[42:43], v[84:85], v[86:87]
    v_pk_fma_f32 v[128:129], v[44:45], v[84:85], v[86:87]
    v_pk_fma_f32 v[130:131], v[46:47], v[84:85], v[86:87]
    v_pk_fma_f32 v[124:125], v[124:125], v[88:89], v[40:41]
    v_pk_fma_f32 v[126:127], v[126:127], v[90:91], v[42:43]
    v_pk_fma_f32 v[128:129], v[128:129], v[92:93], v[44:45]
    v_pk_fma_f32 v[130:131], v[130:131], v[94:95], v[46:47]
    v_cvt_pk_bf16_f32 v108, v124, v125
    v_cvt_pk_bf16_f32 v109, v126, v127
    v_cvt_pk_bf16_f32 v110, v128, v129
    v_cvt_pk_bf16_f32 v111, v130, v131
    ds_write_b128 v10, v[108:111] offset:3072
    s_nop 0
    v_mfma_f32_16x16x32_bf16 v[76:79], v[72:75], v[108:111], v[76:79]
    v_mfma_f32_16x16x32_bf16 v[80:83], v[108:111], v[108:111], v[80:83]
    ds_read_b64_tr_b16 a[96:97], v9 offset:12288
    ds_read_b64_tr_b16 a[98:99], v9 offset:12800
    buffer_load_dwordx4 a[72:75], v7, s[60:63], s72 offen offset:2048 sc1
    buffer_load_dwordx4 a[76:79], v7, s[60:63], s73 offen offset:2048 sc1
    s_waitcnt lgkmcnt(15)
    v_lshlrev_b32 v88, 16, v112
    v_and_b32 v89, 0xffff0000, v112
    v_lshlrev_b32 v90, 16, v113
    v_and_b32 v91, 0xffff0000, v113
    v_lshlrev_b32 v92, 16, v114
    v_and_b32 v93, 0xffff0000, v114
    v_lshlrev_b32 v94, 16, v115
    v_and_b32 v95, 0xffff0000, v115
    v_pk_fma_f32 v[124:125], v[48:49], v[84:85], v[86:87]
    v_pk_fma_f32 v[126:127], v[50:51], v[84:85], v[86:87]
    v_pk_fma_f32 v[128:129], v[52:53], v[84:85], v[86:87]
    v_pk_fma_f32 v[130:131], v[54:55], v[84:85], v[86:87]
    v_pk_fma_f32 v[124:125], v[124:125], v[88:89], v[48:49]
    v_pk_fma_f32 v[126:127], v[126:127], v[90:91], v[50:51]
    v_pk_fma_f32 v[128:129], v[128:129], v[92:93], v[52:53]
    v_pk_fma_f32 v[130:131], v[130:131], v[94:95], v[54:55]
    v_cvt_pk_bf16_f32 v112, v124, v125
    v_cvt_pk_bf16_f32 v113, v126, v127
    v_cvt_pk_bf16_f32 v114, v128, v129
    v_cvt_pk_bf16_f32 v115, v130, v131
    ds_write_b128 v10, v[112:115] offset:4096
    s_nop 0
    v_mfma_f32_16x16x32_bf16 v[76:79], v[72:75], v[112:115], v[76:79]
    v_mfma_f32_16x16x32_bf16 v[80:83], v[112:115], v[112:115], v[80:83]
    ds_read_b64_tr_b16 a[100:101], v9 offset:16384
    ds_read_b64_tr_b16 a[102:103], v9 offset:16896
    buffer_load_dwordx4 a[80:83], v7, s[60:63], s74 offen offset:2048 sc1
    s_waitcnt lgkmcnt(15)
    v_lshlrev_b32 v88, 16, v116
    v_and_b32 v89, 0xffff0000, v116
    v_lshlrev_b32 v90, 16, v117
    v_and_b32 v91, 0xffff0000, v117
    v_lshlrev_b32 v92, 16, v118
    v_and_b32 v93, 0xffff0000, v118
    v_lshlrev_b32 v94, 16, v119
    v_and_b32 v95, 0xffff0000, v119
    v_pk_fma_f32 v[124:125], v[56:57], v[84:85], v[86:87]
    v_pk_fma_f32 v[126:127], v[58:59], v[84:85], v[86:87]
    v_pk_fma_f32 v[128:129], v[60:61], v[84:85], v[86:87]
    v_pk_fma_f32 v[130:131], v[62:63], v[84:85], v[86:87]
    v_pk_fma_f32 v[124:125], v[124:125], v[88:89], v[56:57]
    v_pk_fma_f32 v[126:127], v[126:127], v[90:91], v[58:59]
    v_pk_fma_f32 v[128:129], v[128:129], v[92:93], v[60:61]
    v_pk_fma_f32 v[130:131], v[130:131], v[94:95], v[62:63]
    v_cvt_pk_bf16_f32 v116, v124, v125
    v_cvt_pk_bf16_f32 v117, v126, v127
    v_cvt_pk_bf16_f32 v118, v128, v129
    v_cvt_pk_bf16_f32 v119, v130, v131
    ds_write_b128 v10, v[116:119] offset:5120
    s_nop 0
    v_mfma_f32_16x16x32_bf16 v[76:79], v[72:75], v[116:119], v[76:79]
    v_mfma_f32_16x16x32_bf16 v[80:83], v[116:119], v[116:119], v[80:83]
    ds_read_b64_tr_b16 a[104:105], v9 offset:20480
    ds_read_b64_tr_b16 a[106:107], v9 offset:20992
    v_lshlrev_b32 v88, 16, v120
    v_and_b32 v89, 0xffff0000, v120
    v_lshlrev_b32 v90, 16, v121
    v_and_b32 v91, 0xffff0000, v121
    v_lshlrev_b32 v92, 16, v122
    v_and_b32 v93, 0xffff0000, v122
    v_lshlrev_b32 v94, 16, v123
    v_and_b32 v95, 0xffff0000, v123
    v_pk_fma_f32 v[124:125], v[64:65], v[84:85], v[86:87]
    v_pk_fma_f32 v[126:127], v[66:67], v[84:85], v[86:87]
    v_pk_fma_f32 v[128:129], v[68:69], v[84:85], v[86:87]
    v_pk_fma_f32 v[130:131], v[70:71], v[84:85], v[86:87]
    v_pk_fma_f32 v[124:125], v[124:125], v[88:89], v[64:65]
    v_pk_fma_f32 v[126:127], v[126:127], v[90:91], v[66:67]
    v_pk_fma_f32 v[128:129], v[128:129], v[92:93], v[68:69]
    v_pk_fma_f32 v[130:131], v[130:131], v[94:95], v[70:71]
    v_cvt_pk_bf16_f32 v120, v124, v125
    v_cvt_pk_bf16_f32 v121, v126, v127
    v_cvt_pk_bf16_f32 v122, v128, v129
    v_cvt_pk_bf16_f32 v123, v130, v131
    ds_write_b128 v10, v[120:123] offset:6144
    s_nop 0
    v_mfma_f32_16x16x32_bf16 v[76:79], v[72:75], v[120:123], v[76:79]
    v_mfma_f32_16x16x32_bf16 v[80:83], v[120:123], v[120:123], v[80:83]
    ds_read_b64_tr_b16 a[108:109], v9 offset:24576
    ds_read_b64_tr_b16 a[110:111], v9 offset:25088
    s_lshl_b32 s10, s3, 8
    s_add_u32 s10, s10, 160256
    v_lshl_add_u32 v124, v4, 4, s10
    v_lshl_add_u32 v125, v3, 2, s10
    v_mov_b32 v128, s78
    v_mov_b32 v129, s78
    v_mov_b32 v130, s78
    v_mov_b32 v131, s78
    ds_write_b128 v14, v[80:83] offset:10240
    ds_write_b32 v15, v76 offset:10240
    s_mul_i32 s10, s7, 35840
    v_add_u32 v8, s10, v5
    s_mul_i32 s10, s7, -21504
    s_add_u32 s10, s10, 28672
    v_add_u32 v9, s10, v5
    s_mul_i32 s10, s6, 14336
    s_lshl_b32 s11, s5, 11
    s_add_u32 s10, s10, s11
    s_lshl_b32 s11, s7, 10
    s_add_u32 s10, s10, s11
    v_add_u32 v10, s10, v5
    v_mov_b32 v100, v76
    s_waitcnt lgkmcnt(0)
    s_barrier
    ds_read_b128 v[64:67], v9 offset:0
    ds_read_b128 v[68:71], v9 offset:14336
    ds_read_b128 v[72:75], v9 offset:1024
    ds_read_b128 v[76:79], v9 offset:15360
    ds_read_b128 v[112:115], v10
    ds_read_b32 v96, v11 offset:10240
    ds_read_b32 v97, v12 offset:10240
    ds_read_b32 v98, v13 offset:10240
    ds_read_b128 v[80:83], v9 offset:2048
    ds_read_b128 v[84:87], v9 offset:16384
    ds_read_b128 v[88:91], v9 offset:3072
    ds_read_b128 v[92:95], v9 offset:17408
    s_waitcnt lgkmcnt(11)
    v_mfma_f32_16x16x32_bf16 v[40:43], a[0:3], v[64:67], 0
    s_mul_i32 s10, s3, 6144
    s_add_u32 s10, s10, 65536
    v_mfma_f32_16x16x32_bf16 v[44:47], a[4:7], v[64:67], 0
    v_add_u32 v10, s10, v5
    s_xor_b32 s11, s3, 1
    v_mfma_f32_16x16x32_bf16 v[48:51], v[64:67], a[8:11], 0
    s_mul_i32 s11, s11, 6144
    s_add_u32 s11, s11, 65536
    ds_read_b128 v[64:67], v9 offset:4096
    s_waitcnt lgkmcnt(11)
    v_mfma_f32_16x16x32_bf16 v[52:55], a[0:3], v[68:71], 0
    v_add_u32 v11, s11, v5
    s_waitcnt lgkmcnt(5)
    v_mfma_f32_16x16x32_bf16 v[56:59], a[4:7], v[68:71], 0
    v_add_f32 v96, v96, v97
    v_add_f32 v100, v100, v98
    v_mfma_f32_16x16x32_bf16 v[60:63], v[68:71], a[8:11], 0
    v_mul_f32 v100, s76, v100
    v_mul_f32 v96, s76, v96
    ds_read_b128 v[68:71], v9 offset:18432
    v_mfma_f32_16x16x32_bf16 v[40:43], a[12:15], v[72:75], v[40:43]
    v_fma_f32 v96, -v100, v100, v96
    v_max_f32 v96, 0, v96
    v_mfma_f32_16x16x32_bf16 v[44:47], a[16:19], v[72:75], v[44:47]
    v_cvt_pk_bf16_f32 v97, v100, v96
    v_lshlrev_b32 v100, 16, v97
    v_mfma_f32_16x16x32_bf16 v[48:51], v[72:75], a[20:23], v[48:51]
    v_and_b32 v96, 0xffff0000, v97
    v_add_f32 v96, s77, v96
    ds_read_b128 v[72:75], v9 offset:5120
    v_mfma_f32_16x16x32_bf16 v[52:55], a[12:15], v[76:79], v[52:55]
    v_cvt_pk_bf16_f32 v97, v100, v96
    v_lshlrev_b32 v100, 16, v97
    v_mfma_f32_16x16x32_bf16 v[56:59], a[16:19], v[76:79], v[56:59]
    v_and_b32 v96, 0xffff0000, v97
    v_sqrt_f32 v96, v96
    v_mfma_f32_16x16x32_bf16 v[60:63], v[76:79], a[20:23], v[60:63]
    v_cvt_pk_bf16_f32 v97, v100, v96
    v_lshlrev_b32 v100, 16, v97
    ds_read_b128 v[76:79], v9 offset:19456
    s_waitcnt lgkmcnt(7)
    v_mfma_f32_16x16x32_bf16 v[40:43], a[24:27], v[80:83], v[40:43]
    v_and_b32 v96, 0xffff0000, v97
    v_rcp_f32 v101, v96
    v_mfma_f32_16x16x32_bf16 v[44:47], a[28:31], v[80:83], v[44:47]
    v_mul_f32 v102, -v100, v101
    s_lshl_b32 s10, s6, 6
    v_mfma_f32_16x16x32_bf16 v[48:51], v[80:83], a[32:35], v[48:51]
    s_add_u32 s10, s10, 159744
    v_lshl_add_u32 v103, v3, 2, s10
    ds_read_b128 v[80:83], v9 offset:6144
    s_waitcnt lgkmcnt(7)
    v_mfma_f32_16x16x32_bf16 v[52:55], a[24:27], v[84:87], v[52:55]
    ds_write_b32 v103, v101
    ds_write_b32 v103, v102 offset:256
    v_mfma_f32_16x16x32_bf16 v[56:59], a[28:31], v[84:87], v[56:59]
    s_lshl_b32 s10, s3, 10
    s_add_u32 s10, s10, 131072
    v_mfma_f32_16x16x32_bf16 v[60:63], v[84:87], a[32:35], v[60:63]
    v_add_u32 v104, s10, v5
    ds_write_b128 v104, v[112:115]
    ds_read_b128 v[84:87], v9 offset:20480
    s_waitcnt lgkmcnt(10)
    v_mfma_f32_16x16x32_bf16 v[40:43], a[36:39], v[88:91], v[40:43]
    s_lshl_b32 s13, s5, 2
    s_add_u32 s13, s13, s6
    v_mfma_f32_16x16x32_bf16 v[44:47], a[40:43], v[88:91], v[44:47]
    s_lshl_b32 s64, s13, 17
    s_lshl_b32 s65, s4, 12
    v_mfma_f32_16x16x32_bf16 v[48:51], v[88:91], a[44:47], v[48:51]
    s_add_u32 s64, s64, s65
    s_lshl_b32 s65, s7, 11
    ds_read_b128 v[88:91], v8 offset:0
    s_waitcnt lgkmcnt(10)
    v_mfma_f32_16x16x32_bf16 v[52:55], a[36:39], v[92:95], v[52:55]
    s_add_u32 s64, s64, s65
    s_add_u32 s64, s64, 10485760
    v_mfma_f32_16x16x32_bf16 v[56:59], a[40:43], v[92:95], v[56:59]
    s_lshl_b32 s65, s5, 1
    s_lshr_b32 s66, s6, 1
    v_mfma_f32_16x16x32_bf16 v[60:63], v[92:95], a[44:47], v[60:63]
    s_add_u32 s65, s65, s66
    s_lshl_b32 s65, s65, 6
    ds_read_b128 v[92:95], v8 offset:1024
    s_waitcnt vmcnt(6)
    v_mfma_f32_16x16x32_bf16 a[112:115], a[48:51], v[128:131], a[112:115]
    v_mfma_f32_16x16x32_bf16 a[116:119], a[52:55], v[128:131], a[116:119]
    v_mfma_f32_16x16x32_bf16 a[120:123], v[128:131], a[56:59], a[120:123]
    s_waitcnt lgkmcnt(10)
    v_mfma_f32_16x16x32_bf16 v[40:43], a[48:51], v[64:67], v[40:43]
    s_lshl_b32 s66, s4, 1
    s_add_u32 s65, s65, s66
    v_mfma_f32_16x16x32_bf16 v[44:47], a[52:55], v[64:67], v[44:47]
    s_add_u32 s65, s65, s7
    s_lshl_b32 s65, s65, 1
    v_mfma_f32_16x16x32_bf16 v[48:51], v[64:67], a[56:59], v[48:51]
    s_and_b32 s66, s6, 1
    s_add_u32 s65, s65, s66
    ds_read_b128 v[64:67], v8 offset:2048
    s_waitcnt lgkmcnt(10)
    v_mfma_f32_16x16x32_bf16 v[52:55], a[48:51], v[68:71], v[52:55]
    s_lshl_b32 s65, s65, 10
    s_add_u32 s65, s65, 14680064
    v_mfma_f32_16x16x32_bf16 v[56:59], a[52:55], v[68:71], v[56:59]
    s_lshl_b32 s66, s66, 4
    s_sub_u32 s66, 28, s66
    v_mfma_f32_16x16x32_bf16 v[60:63], v[68:71], a[56:59], v[60:63]
    v_cmp_eq_u32 vcc, s66, v3
    v_mov_b32 v14, s78
    ds_read_b128 v[68:71], v8 offset:3072
    s_waitcnt vmcnt(3)
    v_mfma_f32_16x16x32_bf16 a[112:115], a[60:63], v[128:131], a[112:115]
    v_mfma_f32_16x16x32_bf16 a[116:119], a[64:67], v[128:131], a[116:119]
    v_mfma_f32_16x16x32_bf16 a[120:123], v[128:131], a[68:71], a[120:123]
    s_waitcnt lgkmcnt(10)
    v_mfma_f32_16x16x32_bf16 v[40:43], a[60:63], v[72:75], v[40:43]
    s_lshl_b32 s10, s7, 7
    s_add_u32 s10, s10, 159744
    v_mfma_f32_16x16x32_bf16 v[44:47], a[64:67], v[72:75], v[44:47]
    v_lshl_add_u32 v12, v3, 2, s10
    v_lshl_add_u32 v13, v4, 4, s10
    v_mfma_f32_16x16x32_bf16 v[48:51], v[72:75], a[68:71], v[48:51]
    ds_read_b128 v[72:75], v8 offset:4096
    s_waitcnt lgkmcnt(10)
    v_mfma_f32_16x16x32_bf16 v[52:55], a[60:63], v[76:79], v[52:55]
    v_mfma_f32_16x16x32_bf16 v[56:59], a[64:67], v[76:79], v[56:59]
    v_mfma_f32_16x16x32_bf16 v[60:63], v[76:79], a[68:71], v[60:63]
    ds_read_b128 v[76:79], v8 offset:5120
    s_waitcnt vmcnt(0)
    v_mfma_f32_16x16x32_bf16 a[112:115], a[72:75], v[128:131], a[112:115]
    v_mfma_f32_16x16x32_bf16 a[116:119], a[76:79], v[128:131], a[116:119]
    v_mfma_f32_16x16x32_bf16 a[120:123], v[128:131], a[80:83], a[120:123]
    s_waitcnt lgkmcnt(10)
    v_mfma_f32_16x16x32_bf16 v[40:43], a[72:75], v[80:83], v[40:43]
    v_mfma_f32_16x16x32_bf16 v[44:47], a[76:79], v[80:83], v[44:47]
    v_mfma_f32_16x16x32_bf16 v[48:51], v[80:83], a[80:83], v[48:51]
    ds_read_b128 v[80:83], v8 offset:6144
    s_waitcnt lgkmcnt(7)
    v_mfma_f32_16x16x32_bf16 v[52:55], a[72:75], v[84:87], v[52:55]
    v_mfma_f32_16x16x32_bf16 v[56:59], a[76:79], v[84:87], v[56:59]
    v_mfma_f32_16x16x32_bf16 v[60:63], v[84:87], a[80:83], v[60:63]
    ds_read_b128 v[84:87], v8 offset:14336
    s_waitcnt lgkmcnt(7)
    v_mfma_f32_16x16x32_bf16 v[16:19], a[0:3], v[88:91], 0
    v_mfma_f32_16x16x32_bf16 v[20:23], a[4:7], v[88:91], 0
    v_mfma_f32_16x16x32_bf16 v[24:27], v[88:91], a[8:11], 0
    ds_read_b128 v[88:91], v8 offset:15360
    ds_write_b128 v124, a[112:115]
    ds_write_b128 v124, a[116:119] offset:64
    ds_write_b32 v125, a120 offset:128
    v_xor_b32 v124, 256, v124
    v_xor_b32 v125, 256, v125
    ds_write_b128 v10, v[40:43] offset:0
    s_waitcnt lgkmcnt(11)
    v_mfma_f32_16x16x32_bf16 v[16:19], a[12:15], v[92:95], v[16:19]
    v_mfma_f32_16x16x32_bf16 v[20:23], a[16:19], v[92:95], v[20:23]
    v_mfma_f32_16x16x32_bf16 v[24:27], v[92:95], a[20:23], v[24:27]
    ds_read_b128 v[92:95], v8 offset:16384
    ds_write_b128 v10, v[44:47] offset:1024
    s_waitcnt lgkmcnt(12)
    v_mfma_f32_16x16x32_bf16 v[16:19], a[24:27], v[64:67], v[16:19]
    v_mfma_f32_16x16x32_bf16 v[20:23], a[28:31], v[64:67], v[20:23]
    v_mfma_f32_16x16x32_bf16 v[24:27], v[64:67], a[32:35], v[24:27]
    ds_read_b128 v[64:67], v8 offset:17408
    ds_write_b128 v10, v[48:51] offset:2048
    s_waitcnt lgkmcnt(13)
    v_mfma_f32_16x16x32_bf16 v[16:19], a[36:39], v[68:71], v[16:19]
    v_mfma_f32_16x16x32_bf16 v[20:23], a[40:43], v[68:71], v[20:23]
    v_mfma_f32_16x16x32_bf16 v[24:27], v[68:71], a[44:47], v[24:27]
    ds_read_b128 v[68:71], v8 offset:18432
    ds_write_b128 v10, v[52:55] offset:3072
    s_waitcnt lgkmcnt(14)
    v_mfma_f32_16x16x32_bf16 v[16:19], a[48:51], v[72:75], v[16:19]
    v_mfma_f32_16x16x32_bf16 v[20:23], a[52:55], v[72:75], v[20:23]
    v_mfma_f32_16x16x32_bf16 v[24:27], v[72:75], a[56:59], v[24:27]
    ds_read_b128 v[72:75], v8 offset:19456
    ds_write_b128 v10, v[56:59] offset:4096
    s_waitcnt lgkmcnt(15)
    v_mfma_f32_16x16x32_bf16 v[16:19], a[60:63], v[76:79], v[16:19]
    v_mfma_f32_16x16x32_bf16 v[20:23], a[64:67], v[76:79], v[20:23]
    v_mfma_f32_16x16x32_bf16 v[24:27], v[76:79], a[68:71], v[24:27]
    ds_read_b128 v[76:79], v8 offset:20480
    ds_write_b128 v10, v[60:63] offset:5120
    s_waitcnt lgkmcnt(15)
    v_mfma_f32_16x16x32_bf16 v[16:19], a[72:75], v[80:83], v[16:19]
    v_mfma_f32_16x16x32_bf16 v[20:23], a[76:79], v[80:83], v[20:23]
    v_mfma_f32_16x16x32_bf16 v[24:27], v[80:83], a[80:83], v[24:27]
    s_waitcnt lgkmcnt(0)
    s_barrier
    ds_read_b128 v[52:55], v124
    ds_read_b128 v[56:59], v124 offset:64
    ds_read_b32 v60, v125 offset:128
    v_accvgpr_read_b32 v40, a112
    v_accvgpr_read_b32 v41, a113
    v_accvgpr_read_b32 v42, a114
    v_accvgpr_read_b32 v43, a115
    v_accvgpr_read_b32 v44, a116
    v_accvgpr_read_b32 v45, a117
    v_accvgpr_read_b32 v46, a118
    v_accvgpr_read_b32 v47, a119
    v_accvgpr_read_b32 v48, a120
    v_mfma_f32_16x16x32_bf16 v[28:31], a[0:3], v[84:87], 0
    v_mfma_f32_16x16x32_bf16 v[32:35], a[4:7], v[84:87], 0
    v_mfma_f32_16x16x32_bf16 v[36:39], v[84:87], a[8:11], 0
    s_waitcnt lgkmcnt(0)
    v_add_f32 v40, v40, v52
    v_accvgpr_write_b32 a112, v40
    v_add_f32 v41, v41, v53
    v_accvgpr_write_b32 a113, v41
    v_add_f32 v42, v42, v54
    v_accvgpr_write_b32 a114, v42
    v_add_f32 v43, v43, v55
    v_accvgpr_write_b32 a115, v43
    v_add_f32 v44, v44, v56
    v_accvgpr_write_b32 a116, v44
    v_add_f32 v45, v45, v57
    v_accvgpr_write_b32 a117, v45
    v_add_f32 v46, v46, v58
    v_accvgpr_write_b32 a118, v46
    v_add_f32 v47, v47, v59
    v_accvgpr_write_b32 a119, v47
    v_add_f32 v48, v48, v60
    v_accvgpr_write_b32 a120, v48
    v_mov_b32 v49, v48
    ds_read_b128 v[96:99], v11 offset:0
    ds_read_b128 v[100:103], v11 offset:1024
    ds_read_b128 v[104:107], v11 offset:2048
    ds_read_b128 v[108:111], v11 offset:3072
    ds_read_b128 v[112:115], v11 offset:4096
    ds_read_b128 v[116:119], v11 offset:5120
    ds_read_b32 v120, v12 offset:0
    ds_read_b32 v122, v12 offset:256
    ds_read_b128 v[50:53], v13 offset:0
    ds_read_b128 v[54:57], v13 offset:256
    v_mfma_f32_16x16x32_bf16 v[28:31], a[12:15], v[88:91], v[28:31]
    v_mfma_f32_16x16x32_bf16 v[32:35], a[16:19], v[88:91], v[32:35]
    v_mfma_f32_16x16x32_bf16 v[36:39], v[88:91], a[20:23], v[36:39]
    v_mfma_f32_16x16x32_bf16 v[28:31], a[24:27], v[92:95], v[28:31]
    v_mfma_f32_16x16x32_bf16 v[32:35], a[28:31], v[92:95], v[32:35]
    v_mfma_f32_16x16x32_bf16 v[36:39], v[92:95], a[32:35], v[36:39]
    v_mfma_f32_16x16x32_bf16 v[28:31], a[36:39], v[64:67], v[28:31]
    v_mfma_f32_16x16x32_bf16 v[32:35], a[40:43], v[64:67], v[32:35]
    v_mfma_f32_16x16x32_bf16 v[36:39], v[64:67], a[44:47], v[36:39]
    s_waitcnt lgkmcnt(0)
    v_mov_b32 v121, v120
    v_mov_b32 v123, v122
    v_add_f32 v16, v16, v96
    v_add_f32 v17, v17, v97
    v_add_f32 v18, v18, v98
    v_add_f32 v19, v19, v99
    v_add_f32 v20, v20, v100
    v_add_f32 v21, v21, v101
    v_add_f32 v22, v22, v102
    v_add_f32 v23, v23, v103
    v_add_f32 v24, v24, v104
    v_add_f32 v25, v25, v105
    v_add_f32 v26, v26, v106
    v_add_f32 v27, v27, v107
    v_mfma_f32_16x16x32_bf16 v[28:31], a[48:51], v[68:71], v[28:31]
    v_mfma_f32_16x16x32_bf16 v[32:35], a[52:55], v[68:71], v[32:35]
    v_mfma_f32_16x16x32_bf16 v[36:39], v[68:71], a[56:59], v[36:39]
    v_pk_mul_f32 v[58:59], v[40:41], v[122:123]
    v_pk_fma_f32 v[16:17], v[16:17], v[120:121], v[58:59]
    v_cvt_pk_bf16_f32 v60, v16, v17
    v_pk_mul_f32 v[58:59], v[42:43], v[122:123]
    v_pk_fma_f32 v[18:19], v[18:19], v[120:121], v[58:59]
    v_cvt_pk_bf16_f32 v61, v18, v19
    v_mfma_f32_16x16x32_bf16 v[28:31], a[60:63], v[72:75], v[28:31]
    v_mfma_f32_16x16x32_bf16 v[32:35], a[64:67], v[72:75], v[32:35]
    v_mfma_f32_16x16x32_bf16 v[36:39], v[72:75], a[68:71], v[36:39]
    v_pk_mul_f32 v[58:59], v[44:45], v[122:123]
    v_pk_fma_f32 v[20:21], v[20:21], v[120:121], v[58:59]
    v_cvt_pk_bf16_f32 v62, v20, v21
    v_pk_mul_f32 v[58:59], v[46:47], v[122:123]
    v_pk_fma_f32 v[22:23], v[22:23], v[120:121], v[58:59]
    v_cvt_pk_bf16_f32 v63, v22, v23
    v_mfma_f32_16x16x32_bf16 v[28:31], a[72:75], v[76:79], v[28:31]
    v_mfma_f32_16x16x32_bf16 v[32:35], a[76:79], v[76:79], v[32:35]
    v_mfma_f32_16x16x32_bf16 v[36:39], v[76:79], a[80:83], v[36:39]
    buffer_store_dwordx4 v[60:63], v5, s[60:63], s64 offen offset:0 sc1
    v_pk_mul_f32 v[58:59], v[48:49], v[54:55]
    v_pk_fma_f32 v[24:25], v[24:25], v[50:51], v[58:59]
    v_cvt_pk_bf16_f32 v124, v24, v25
    v_pk_mul_f32 v[58:59], v[48:49], v[56:57]
    v_pk_fma_f32 v[26:27], v[26:27], v[52:53], v[58:59]
    v_cvt_pk_bf16_f32 v125, v26, v27
    ds_read_b32 v120, v12 offset:64
    ds_read_b32 v122, v12 offset:320
    ds_read_b128 v[50:53], v13 offset:64
    ds_read_b128 v[54:57], v13 offset:320
    s_waitcnt lgkmcnt(0)
    v_mov_b32 v121, v120
    v_mov_b32 v123, v122
    v_add_f32 v28, v28, v108
    v_add_f32 v29, v29, v109
    v_add_f32 v30, v30, v110
    v_add_f32 v31, v31, v111
    v_add_f32 v32, v32, v112
    v_add_f32 v33, v33, v113
    v_add_f32 v34, v34, v114
    v_add_f32 v35, v35, v115
    v_add_f32 v36, v36, v116
    v_add_f32 v37, v37, v117
    v_add_f32 v38, v38, v118
    v_add_f32 v39, v39, v119
    v_pk_mul_f32 v[58:59], v[40:41], v[122:123]
    v_pk_fma_f32 v[28:29], v[28:29], v[120:121], v[58:59]
    v_cvt_pk_bf16_f32 v96, v28, v29
    v_pk_mul_f32 v[58:59], v[42:43], v[122:123]
    v_pk_fma_f32 v[30:31], v[30:31], v[120:121], v[58:59]
    v_cvt_pk_bf16_f32 v97, v30, v31
    v_pk_mul_f32 v[58:59], v[44:45], v[122:123]
    v_pk_fma_f32 v[32:33], v[32:33], v[120:121], v[58:59]
    v_cvt_pk_bf16_f32 v98, v32, v33
    v_pk_mul_f32 v[58:59], v[46:47], v[122:123]
    v_pk_fma_f32 v[34:35], v[34:35], v[120:121], v[58:59]
    v_cvt_pk_bf16_f32 v99, v34, v35
    buffer_store_dwordx4 v[96:99], v5, s[60:63], s64 offen offset:1024 sc1
    v_pk_mul_f32 v[58:59], v[48:49], v[54:55]
    v_pk_fma_f32 v[36:37], v[36:37], v[50:51], v[58:59]
    v_cvt_pk_bf16_f32 v126, v36, v37
    v_pk_mul_f32 v[58:59], v[48:49], v[56:57]
    v_pk_fma_f32 v[38:39], v[38:39], v[52:53], v[58:59]
    v_cvt_pk_bf16_f32 v127, v38, v39
    v_cndmask_b32 v124, v124, v14, vcc
    v_cndmask_b32 v125, v125, v14, vcc
    v_cndmask_b32 v126, v126, v14, vcc
    v_cndmask_b32 v127, v127, v14, vcc
    buffer_store_dwordx4 v[124:127], v5, s[60:63], s65 offen sc1
    s_lshl_b32 s12, s4, 3
    s_add_u32 s12, s12, s5
    s_waitcnt vmcnt(0)
    s_barrier
    s_cmp_lg_u32 s3, 0
    s_cbranch_scc1 m_sig13
    s_lshl_b32 s10, s12, 7
    s_add_u32 s10, s10, 9535488
    v_mov_b32 v10, 0
    v_mov_b32 v8, s56
    v_mov_b32 v9, s57
    s_mov_b64 exec, 1
    buffer_store_dwordx2 v[8:9], v10, s[60:63], s10 offen sc1
    s_mov_b64 exec, -1
m_sig13:
    s_cmp_eq_u32 s7, 1
    s_cselect_b64 s[64:65], -1, 0
    v_mov_b32 v52, 0xf149f2ca
    v_lshlrev_b32 v53, 2, v4
    v_add_u32 v54, 0, v53
    v_cmp_gt_u32 vcc, v54, v3
    s_nop 1
    v_cndmask_b32 v16, v52, 0, vcc
    v_cndmask_b32 v17, 0, v52, vcc
    v_cndmask_b32 v56, v16, v52, s[64:65]
    v_cndmask_b32 v60, 0, v16, s[64:65]
    v_cndmask_b32 v120, v17, 0, s[64:65]
    v_cndmask_b32 v124, v52, v17, s[64:65]
    v_add_u32 v54, 1, v53
    v_cmp_gt_u32 vcc, v54, v3
    s_nop 1
    v_cndmask_b32 v16, v52, 0, vcc
    v_cndmask_b32 v17, 0, v52, vcc
    v_cndmask_b32 v57, v16, v52, s[64:65]
    v_cndmask_b32 v61, 0, v16, s[64:65]
    v_cndmask_b32 v121, v17, 0, s[64:65]
    v_cndmask_b32 v125, v52, v17, s[64:65]
    v_add_u32 v54, 2, v53
    v_cmp_gt_u32 vcc, v54, v3
    s_nop 1
    v_cndmask_b32 v16, v52, 0, vcc
    v_cndmask_b32 v17, 0, v52, vcc
    v_cndmask_b32 v58, v16, v52, s[64:65]
    v_cndmask_b32 v62, 0, v16, s[64:65]
    v_cndmask_b32 v122, v17, 0, s[64:65]
    v_cndmask_b32 v126, v52, v17, s[64:65]
    v_add_u32 v54, 3, v53
    v_cmp_gt_u32 vcc, v54, v3
    s_nop 1
    v_cndmask_b32 v16, v52, 0, vcc
    v_cndmask_b32 v17, 0, v52, vcc
    v_cndmask_b32 v59, v16, v52, s[64:65]
    v_cndmask_b32 v63, 0, v16, s[64:65]
    v_cndmask_b32 v123, v17, 0, s[64:65]
    v_cndmask_b32 v127, v52, v17, s[64:65]
    s_lshl_b32 s12, s9, 17
    s_add_u32 s40, s38, 10485760
    s_addc_u32 s41, s39, 0
    s_add_u32 s40, s40, s12
    s_addc_u32 s41, s41, 0
    s_mov_b32 s42, 131072
    s_mov_b32 s43, 0x00020000
    s_add_u32 s44, s38, 12582912
    s_addc_u32 s45, s39, 0
    s_add_u32 s44, s44, s12
    s_addc_u32 s45, s45, 0
    s_mov_b32 s46, 131072
    s_mov_b32 s47, 0x00020000
    s_add_u32 s48, s38, 14680064
    s_addc_u32 s49, s39, 0
    s_add_u32 s48, s48, s12
    s_addc_u32 s49, s49, 0
    s_mov_b32 s50, 131072
    s_mov_b32 s51, 0x00020000
    s_lshl_b32 s64, s8, 3
    s_mul_i32 s65, s3, 3
    s_add_u32 s66, s64, s65
    s_sub_u32 s58, s66, 16
    s_lshl_b32 s66, s58, 10
    v_add_u32 v18, s66, v5
    v_add_u32 v19, 1024, v18
    v_add_u32 v20, 2048, v18
    s_add_u32 s67, s64, s3
    s_lshl_b32 s68, s67, 10
    s_and_b32 s69, s3, 6
    s_lshl_b32 s12, s69, 10
    v_add_u32 v55, s12, v5
    s_cmp_eq_u32 s3, 0
    s_nop 0
    s_cbranch_scc1 m_nwoa0
    s_mov_b32 s52, s32
    s_mov_b32 s53, s33
    s_mov_b32 s54, 401408
    s_mov_b32 s55, 0x00020000
    v_lshrrev_b32 v48, 3, v2
    v_mul_u32_u24 v49, 896, v48
    v_bfe_u32 v48, v2, 4, 1
    v_lshlrev_b32 v48, 2, v48
    v_and_b32 v50, 7, v2
    v_xor_b32 v48, v48, v50
    v_lshl_add_u32 v49, v48, 4, v49
    s_sub_u32 s12, s3, 1
    s_mul_i32 s10, s12, 57344
    s_lshl_b32 s11, s5, 7
    s_add_u32 s10, s10, s11
    s_lshl_b32 s11, s12, 13
    s_add_u32 s11, s11, 65536
    s_mov_b32 m0, s11
    s_nop 0
    buffer_load_dwordx4 v49, s[52:55], s10 offen lds
    s_add_u32 s10, s10, 7168
    s_add_u32 s11, s11, 1024
    s_mov_b32 m0, s11
    s_nop 0
    buffer_load_dwordx4 v49, s[52:55], s10 offen lds
    s_add_u32 s10, s10, 7168
    s_add_u32 s11, s11, 1024
    s_mov_b32 m0, s11
    s_nop 0
    buffer_load_dwordx4 v49, s[52:55], s10 offen lds
    s_add_u32 s10, s10, 7168
    s_add_u32 s11, s11, 1024
    s_mov_b32 m0, s11
    s_nop 0
    buffer_load_dwordx4 v49, s[52:55], s10 offen lds
    s_add_u32 s10, s10, 7168
    s_add_u32 s11, s11, 1024
    s_mov_b32 m0, s11
    s_nop 0
    buffer_load_dwordx4 v49, s[52:55], s10 offen lds
    s_add_u32 s10, s10, 7168
    s_add_u32 s11, s11, 1024
    s_mov_b32 m0, s11
    s_nop 0
    buffer_load_dwordx4 v49, s[52:55], s10 offen lds
    s_add_u32 s10, s10, 7168
    s_add_u32 s11, s11, 1024
    s_mov_b32 m0, s11
    s_nop 0
    buffer_load_dwordx4 v49, s[52:55], s10 offen lds
    s_add_u32 s10, s10, 7168
    s_add_u32 s11, s11, 1024
    s_mov_b32 m0, s11
    s_nop 0
    buffer_load_dwordx4 v49, s[52:55], s10 offen lds
m_nwoa0:
    s_cmp_lg_u32 s3, 0
    s_cbranch_scc1 m_wd14
    s_lshl_b32 s10, s8, 4
    s_sub_u32 s10, s10, 32
    v_lshrrev_b32 v8, 2, v2
    v_min_u32 v8, 5, v8
    v_lshlrev_b32 v8, 3, v8
    v_add_u32 v8, s10, v8
    v_max_i32 v8, 0, v8
    s_lshr_b32 s11, s9, 2
    s_lshr_b32 s12, s9, 1
    v_and_b32 v9, 1, v2
    v_lshlrev_b32 v9, 2, v9
    v_add_u32 v9, s11, v9
    v_mov_b32 v10, s12
    v_and_b32 v11, 2, v2
    v_cmp_eq_u32 vcc, 0, v11
    s_nop 1
    v_cndmask_b32 v9, v10, v9, vcc
    v_add_u32 v8, v8, v9
    v_lshlrev_b32 v8, 7, v8
    s_mov_b32 s10, 9535488
    s_mov_b32 s11, 0
    buffer_load_dwordx2 v[96:97], v8, s[60:63], s10 offen sc1
    s_sleep 2
m_wl14:
    buffer_load_dwordx2 v[100:101], v8, s[60:63], s10 offen sc1
    s_waitcnt vmcnt(1)
    v_xor_b32 v96, s56, v96
    v_xor_b32 v97, s57, v97
    v_lshrrev_b32 v98, 8, v97
    v_or_b32 v98, v98, v96
    v_cmp_ne_u32 vcc, 0, v98
    s_nop 4
    s_cbranch_vccz m_wa14
    buffer_load_dwordx2 v[96:97], v8, s[60:63], s10 offen sc1
    s_waitcnt vmcnt(1)
    v_xor_b32 v100, s56, v100
    v_xor_b32 v101, s57, v101
    v_lshrrev_b32 v102, 8, v101
    v_or_b32 v102, v102, v100
    v_cmp_ne_u32 vcc, 0, v102
    s_nop 4
    s_cbranch_vccz m_wb14
    s_add_u32 s11, s11, 1
    s_cmp_gt_u32 s11, 200000
    s_cbranch_scc0 m_wl14
    s_branch m_wb14
m_wa14:
m_wb14:
m_wd14:
    s_barrier
    buffer_load_dwordx4 v[12:15], v5, s[40:43], s68 offen sc1
    s_lshl_b32 s12, s65, 10
    s_add_u32 s13, s12, 0
    s_mov_b32 m0, s13
    s_nop 0
    buffer_load_dwordx4 v18, s[44:47], 0 offen sc1 lds
    s_add_u32 s13, s12, 1024
    s_mov_b32 m0, s13
    s_nop 0
    buffer_load_dwordx4 v19, s[44:47], 0 offen sc1 lds
    s_add_u32 s13, s12, 2048
    s_mov_b32 m0, s13
    s_nop 0
    buffer_load_dwordx4 v20, s[44:47], 0 offen sc1 lds
    s_waitcnt vmcnt(0)
    s_add_u32 s13, s12, 24576
    s_mov_b32 m0, s13
    s_nop 0
    buffer_load_dwordx4 v18, s[48:51], 0 offen sc1 lds
    s_add_u32 s13, s12, 25600
    s_mov_b32 m0, s13
    s_nop 0
    buffer_load_dwordx4 v19, s[48:51], 0 offen sc1 lds
    s_add_u32 s13, s12, 26624
    s_mov_b32 m0, s13
    s_nop 0
    buffer_load_dwordx4 v20, s[48:51], 0 offen sc1 lds
    s_barrier
    ds_read_b128 v[16:19], v55 offset:0
    ds_read_b128 v[20:23], v55 offset:1024
    ds_read_b128 v[24:27], v55 offset:2048
    ds_read_b128 v[28:31], v55 offset:3072
    ds_read_b128 v[32:35], v55 offset:4096
    ds_read_b128 v[36:39], v55 offset:5120
    ds_read_b128 v[40:43], v55 offset:6144
    ds_read_b128 v[44:47], v55 offset:7168
    ds_read_b128 v[48:51], v55 offset:8192
    s_waitcnt lgkmcnt(8)
    v_mfma_f32_16x16x32_bf16 v[56:59], v[16:19], v[12:15], v[56:59]
    s_waitcnt lgkmcnt(7)
    v_mfma_f32_16x16x32_bf16 v[60:63], v[20:23], v[12:15], v[60:63]
    s_waitcnt lgkmcnt(6)
    v_mfma_f32_16x16x32_bf16 v[64:67], v[24:27], v[12:15], 0
    s_waitcnt lgkmcnt(5)
    v_mfma_f32_16x16x32_bf16 v[68:71], v[28:31], v[12:15], 0
    s_waitcnt lgkmcnt(4)
    v_mfma_f32_16x16x32_bf16 v[72:75], v[32:35], v[12:15], 0
    s_waitcnt lgkmcnt(3)
    v_mfma_f32_16x16x32_bf16 v[76:79], v[36:39], v[12:15], 0
    s_waitcnt lgkmcnt(2)
    v_mfma_f32_16x16x32_bf16 v[80:83], v[40:43], v[12:15], 0
    s_waitcnt lgkmcnt(1)
    v_mfma_f32_16x16x32_bf16 v[84:87], v[44:47], v[12:15], 0
    s_waitcnt lgkmcnt(0)
    v_mfma_f32_16x16x32_bf16 v[88:91], v[48:51], v[12:15], 0
    ds_read_b128 v[16:19], v55 offset:9216
    ds_read_b128 v[20:23], v55 offset:10240
    ds_read_b128 v[24:27], v55 offset:11264
    ds_read_b128 v[28:31], v55 offset:12288
    ds_read_b128 v[32:35], v55 offset:13312
    ds_read_b128 v[36:39], v55 offset:14336
    ds_read_b128 v[40:43], v55 offset:15360
    ds_read_b128 v[44:47], v55 offset:16384
    ds_read_b128 v[48:51], v55 offset:17408
    s_waitcnt lgkmcnt(8)
    v_mfma_f32_16x16x32_bf16 v[92:95], v[16:19], v[12:15], 0
    s_waitcnt lgkmcnt(7)
    v_mfma_f32_16x16x32_bf16 v[96:99], v[20:23], v[12:15], 0
    s_waitcnt lgkmcnt(6)
    v_mfma_f32_16x16x32_bf16 v[100:103], v[24:27], v[12:15], 0
    s_waitcnt lgkmcnt(5)
    v_mfma_f32_16x16x32_bf16 v[104:107], v[28:31], v[12:15], 0
    s_waitcnt lgkmcnt(4)
    v_mfma_f32_16x16x32_bf16 v[108:111], v[32:35], v[12:15], 0
    s_waitcnt lgkmcnt(3)
    v_mfma_f32_16x16x32_bf16 v[112:115], v[36:39], v[12:15], 0
    s_waitcnt lgkmcnt(2)
    v_mfma_f32_16x16x32_bf16 v[116:119], v[40:43], v[12:15], 0
    s_waitcnt lgkmcnt(1)
    v_mfma_f32_16x16x32_bf16 v[120:123], v[44:47], v[12:15], v[120:123]
    s_waitcnt lgkmcnt(0)
    v_mfma_f32_16x16x32_bf16 v[124:127], v[48:51], v[12:15], v[124:127]
    s_cmp_ge_u32 s8, 2
    s_nop 6
    s_cbranch_scc1 m_nea0
    s_sub_u32 s12, 16, s64
    s_sub_u32 s12, s12, s69
    s_cmp_gt_i32 s12, 0
    s_cselect_b32 s13, 0xf149f2ca, 0
    v_add_f32 v56, s13, v56
    v_add_f32 v57, s13, v57
    v_add_f32 v58, s13, v58
    v_add_f32 v59, s13, v59
    s_cmp_gt_i32 s12, 1
    s_cselect_b32 s13, 0xf149f2ca, 0
    v_add_f32 v60, s13, v60
    v_add_f32 v61, s13, v61
    v_add_f32 v62, s13, v62
    v_add_f32 v63, s13, v63
    s_cmp_gt_i32 s12, 2
    s_cselect_b32 s13, 0xf149f2ca, 0
    v_add_f32 v64, s13, v64
    v_add_f32 v65, s13, v65
    v_add_f32 v66, s13, v66
    v_add_f32 v67, s13, v67
    s_cmp_gt_i32 s12, 3
    s_cselect_b32 s13, 0xf149f2ca, 0
    v_add_f32 v68, s13, v68
    v_add_f32 v69, s13, v69
    v_add_f32 v70, s13, v70
    v_add_f32 v71, s13, v71
    s_cmp_gt_i32 s12, 4
    s_cselect_b32 s13, 0xf149f2ca, 0
    v_add_f32 v72, s13, v72
    v_add_f32 v73, s13, v73
    v_add_f32 v74, s13, v74
    v_add_f32 v75, s13, v75
    s_cmp_gt_i32 s12, 5
    s_cselect_b32 s13, 0xf149f2ca, 0
    v_add_f32 v76, s13, v76
    v_add_f32 v77, s13, v77
    v_add_f32 v78, s13, v78
    v_add_f32 v79, s13, v79
    s_cmp_gt_i32 s12, 6
    s_cselect_b32 s13, 0xf149f2ca, 0
    v_add_f32 v80, s13, v80
    v_add_f32 v81, s13, v81
    v_add_f32 v82, s13, v82
    v_add_f32 v83, s13, v83
    s_cmp_gt_i32 s12, 7
    s_cselect_b32 s13, 0xf149f2ca, 0
    v_add_f32 v84, s13, v84
    v_add_f32 v85, s13, v85
    v_add_f32 v86, s13, v86
    v_add_f32 v87, s13, v87
    s_cmp_gt_i32 s12, 8
    s_cselect_b32 s13, 0xf149f2ca, 0
    v_add_f32 v88, s13, v88
    v_add_f32 v89, s13, v89
    v_add_f32 v90, s13, v90
    v_add_f32 v91, s13, v91
    s_cmp_gt_i32 s12, 9
    s_cselect_b32 s13, 0xf149f2ca, 0
    v_add_f32 v92, s13, v92
    v_add_f32 v93, s13, v93
    v_add_f32 v94, s13, v94
    v_add_f32 v95, s13, v95
    s_cmp_gt_i32 s12, 10
    s_cselect_b32 s13, 0xf149f2ca, 0
    v_add_f32 v96, s13, v96
    v_add_f32 v97, s13, v97
    v_add_f32 v98, s13, v98
    v_add_f32 v99, s13, v99
    s_cmp_gt_i32 s12, 11
    s_cselect_b32 s13, 0xf149f2ca, 0
    v_add_f32 v100, s13, v100
    v_add_f32 v101, s13, v101
    v_add_f32 v102, s13, v102
    v_add_f32 v103, s13, v103
    s_cmp_gt_i32 s12, 12
    s_cselect_b32 s13, 0xf149f2ca, 0
    v_add_f32 v104, s13, v104
    v_add_f32 v105, s13, v105
    v_add_f32 v106, s13, v106
    v_add_f32 v107, s13, v107
    s_cmp_gt_i32 s12, 13
    s_cselect_b32 s13, 0xf149f2ca, 0
    v_add_f32 v108, s13, v108
    v_add_f32 v109, s13, v109
    v_add_f32 v110, s13, v110
    v_add_f32 v111, s13, v111
    s_cmp_gt_i32 s12, 14
    s_cselect_b32 s13, 0xf149f2ca, 0
    v_add_f32 v112, s13, v112
    v_add_f32 v113, s13, v113
    v_add_f32 v114, s13, v114
    v_add_f32 v115, s13, v115
    s_cmp_gt_i32 s12, 15
    s_cselect_b32 s13, 0xf149f2ca, 0
    v_add_f32 v116, s13, v116
    v_add_f32 v117, s13, v117
    v_add_f32 v118, s13, v118
    v_add_f32 v119, s13, v119
    s_nop 1
m_nea0:
    v_max3_f32 v52, v56, v57, v58
    v_max3_f32 v53, v59, v60, v61
    v_max3_f32 v52, v52, v62, v63
    v_max3_f32 v53, v53, v64, v65
    v_max3_f32 v52, v52, v66, v67
    v_max3_f32 v53, v53, v68, v69
    v_max3_f32 v52, v52, v70, v71
    v_max3_f32 v53, v53, v72, v73
    v_max3_f32 v52, v52, v74, v75
    v_max3_f32 v53, v53, v76, v77
    v_max3_f32 v52, v52, v78, v79
    v_max3_f32 v53, v53, v80, v81
    v_max3_f32 v52, v52, v82, v83
    v_max3_f32 v53, v53, v84, v85
    v_max3_f32 v52, v52, v86, v87
    v_max3_f32 v53, v53, v88, v89
    v_max3_f32 v52, v52, v90, v91
    v_max3_f32 v53, v53, v92, v93
    v_max3_f32 v52, v52, v94, v95
    v_max3_f32 v53, v53, v96, v97
    v_max3_f32 v52, v52, v98, v99
    v_max3_f32 v53, v53, v100, v101
    v_max3_f32 v52, v52, v102, v103
    v_max3_f32 v53, v53, v104, v105
    v_max3_f32 v52, v52, v106, v107
    v_max3_f32 v53, v53, v108, v109
    v_max3_f32 v52, v52, v110, v111
    v_max3_f32 v53, v53, v112, v113
    v_max3_f32 v52, v52, v114, v115
    v_max3_f32 v53, v53, v116, v117
    v_max3_f32 v52, v52, v118, v119
    v_max3_f32 v53, v53, v120, v121
    v_max3_f32 v52, v52, v122, v123
    v_max3_f32 v53, v53, v124, v125
    v_max3_f32 v52, v52, v126, v127
    v_max_f32 v52, v52, v53
    v_mov_b32 v53, v52
    s_nop 1
    v_permlane16_swap_b32 v52, v53
    v_max_f32 v52, v52, v53
    v_mov_b32 v53, v52
    s_nop 1
    v_permlane32_swap_b32 v52, v53
    v_max_f32 v52, v52, v53
    v_mul_f32 v52, -v52, s79
    v_mov_b32 v53, v52
    v_mov_b32 v48, s79
    v_mov_b32 v49, s79
    v_fmamk_f32 v56, v56, 0x3e8b97f6, v52
    v_fmamk_f32 v57, v57, 0x3e8b97f6, v52
    v_fmamk_f32 v58, v58, 0x3e8b97f6, v52
    v_fmamk_f32 v59, v59, 0x3e8b97f6, v52
    v_fmamk_f32 v60, v60, 0x3e8b97f6, v52
    v_fmamk_f32 v61, v61, 0x3e8b97f6, v52
    v_fmamk_f32 v62, v62, 0x3e8b97f6, v52
    v_fmamk_f32 v63, v63, 0x3e8b97f6, v52
    v_exp_f32 v56, v56
    v_exp_f32 v57, v57
    v_exp_f32 v58, v58
    v_exp_f32 v59, v59
    v_exp_f32 v60, v60
    v_exp_f32 v61, v61
    v_exp_f32 v62, v62
    v_exp_f32 v63, v63
    v_cvt_pk_bf16_f32 v56, v56, v57
    v_cvt_pk_bf16_f32 v57, v58, v59
    v_cvt_pk_bf16_f32 v58, v60, v61
    v_cvt_pk_bf16_f32 v59, v62, v63
    v_fmamk_f32 v64, v64, 0x3e8b97f6, v52
    v_fmamk_f32 v65, v65, 0x3e8b97f6, v52
    v_fmamk_f32 v66, v66, 0x3e8b97f6, v52
    v_fmamk_f32 v67, v67, 0x3e8b97f6, v52
    v_fmamk_f32 v68, v68, 0x3e8b97f6, v52
    v_fmamk_f32 v69, v69, 0x3e8b97f6, v52
    v_fmamk_f32 v70, v70, 0x3e8b97f6, v52
    v_fmamk_f32 v71, v71, 0x3e8b97f6, v52
    v_exp_f32 v64, v64
    v_exp_f32 v65, v65
    v_exp_f32 v66, v66
    v_exp_f32 v67, v67
    v_exp_f32 v68, v68
    v_exp_f32 v69, v69
    v_exp_f32 v70, v70
    v_exp_f32 v71, v71
    v_cvt_pk_bf16_f32 v64, v64, v65
    v_cvt_pk_bf16_f32 v65, v66, v67
    v_cvt_pk_bf16_f32 v66, v68, v69
    v_cvt_pk_bf16_f32 v67, v70, v71
    v_fmamk_f32 v72, v72, 0x3e8b97f6, v52
    v_fmamk_f32 v73, v73, 0x3e8b97f6, v52
    v_fmamk_f32 v74, v74, 0x3e8b97f6, v52
    v_fmamk_f32 v75, v75, 0x3e8b97f6, v52
    v_fmamk_f32 v76, v76, 0x3e8b97f6, v52
    v_fmamk_f32 v77, v77, 0x3e8b97f6, v52
    v_fmamk_f32 v78, v78, 0x3e8b97f6, v52
    v_fmamk_f32 v79, v79, 0x3e8b97f6, v52
    v_exp_f32 v72, v72
    v_exp_f32 v73, v73
    v_exp_f32 v74, v74
    v_exp_f32 v75, v75
    v_exp_f32 v76, v76
    v_exp_f32 v77, v77
    v_exp_f32 v78, v78
    v_exp_f32 v79, v79
    v_cvt_pk_bf16_f32 v72, v72, v73
    v_cvt_pk_bf16_f32 v73, v74, v75
    v_cvt_pk_bf16_f32 v74, v76, v77
    v_cvt_pk_bf16_f32 v75, v78, v79
    s_waitcnt vmcnt(0)
    s_barrier
    ds_read_b128 v[16:19], v55 offset:24576
    ds_read_b128 v[20:23], v55 offset:25600
    ds_read_b128 v[24:27], v55 offset:26624
    ds_read_b128 v[28:31], v55 offset:27648
    ds_read_b128 v[32:35], v55 offset:28672
    ds_read_b128 v[36:39], v55 offset:29696
    ds_read_b128 v[40:43], v55 offset:30720
    ds_read_b128 v[44:47], v55 offset:31744
    v_fmamk_f32 v80, v80, 0x3e8b97f6, v52
    v_fmamk_f32 v81, v81, 0x3e8b97f6, v52
    v_fmamk_f32 v82, v82, 0x3e8b97f6, v52
    v_fmamk_f32 v83, v83, 0x3e8b97f6, v52
    v_fmamk_f32 v84, v84, 0x3e8b97f6, v52
    v_fmamk_f32 v85, v85, 0x3e8b97f6, v52
    v_fmamk_f32 v86, v86, 0x3e8b97f6, v52
    v_fmamk_f32 v87, v87, 0x3e8b97f6, v52
    v_exp_f32 v80, v80
    v_exp_f32 v81, v81
    v_exp_f32 v82, v82
    v_exp_f32 v83, v83
    v_exp_f32 v84, v84
    v_exp_f32 v85, v85
    v_exp_f32 v86, v86
    v_exp_f32 v87, v87
    v_cvt_pk_bf16_f32 v80, v80, v81
    v_cvt_pk_bf16_f32 v81, v82, v83
    v_cvt_pk_bf16_f32 v82, v84, v85
    v_cvt_pk_bf16_f32 v83, v86, v87
    s_waitcnt lgkmcnt(6)
    v_mfma_f32_16x16x32_bf16 v[8:11], v[16:19], v[56:59], 0
    v_mfma_f32_16x16x32_bf16 v[12:15], v[20:23], v[56:59], 0
    ds_read_b128 v[16:19], v55 offset:32768
    ds_read_b128 v[20:23], v55 offset:33792
    s_waitcnt lgkmcnt(6)
    v_mfma_f32_16x16x32_bf16 v[8:11], v[24:27], v[64:67], v[8:11]
    v_mfma_f32_16x16x32_bf16 v[12:15], v[28:31], v[64:67], v[12:15]
    ds_read_b128 v[24:27], v55 offset:34816
    ds_read_b128 v[28:31], v55 offset:35840
    v_fmamk_f32 v88, v88, 0x3e8b97f6, v52
    v_fmamk_f32 v89, v89, 0x3e8b97f6, v52
    v_fmamk_f32 v90, v90, 0x3e8b97f6, v52
    v_fmamk_f32 v91, v91, 0x3e8b97f6, v52
    v_fmamk_f32 v92, v92, 0x3e8b97f6, v52
    v_fmamk_f32 v93, v93, 0x3e8b97f6, v52
    v_fmamk_f32 v94, v94, 0x3e8b97f6, v52
    v_fmamk_f32 v95, v95, 0x3e8b97f6, v52
    v_exp_f32 v88, v88
    v_exp_f32 v89, v89
    v_exp_f32 v90, v90
    v_exp_f32 v91, v91
    v_exp_f32 v92, v92
    v_exp_f32 v93, v93
    v_exp_f32 v94, v94
    v_exp_f32 v95, v95
    v_cvt_pk_bf16_f32 v88, v88, v89
    v_cvt_pk_bf16_f32 v89, v90, v91
    v_cvt_pk_bf16_f32 v90, v92, v93
    v_cvt_pk_bf16_f32 v91, v94, v95
    s_waitcnt lgkmcnt(6)
    v_mfma_f32_16x16x32_bf16 v[8:11], v[32:35], v[72:75], v[8:11]
    v_mfma_f32_16x16x32_bf16 v[12:15], v[36:39], v[72:75], v[12:15]
    ds_read_b128 v[32:35], v55 offset:36864
    ds_read_b128 v[36:39], v55 offset:37888
    s_waitcnt lgkmcnt(6)
    v_mfma_f32_16x16x32_bf16 v[8:11], v[40:43], v[80:83], v[8:11]
    v_mfma_f32_16x16x32_bf16 v[12:15], v[44:47], v[80:83], v[12:15]
    ds_read_b128 v[40:43], v55 offset:38912
    ds_read_b128 v[44:47], v55 offset:39936
    v_fmamk_f32 v96, v96, 0x3e8b97f6, v52
    v_fmamk_f32 v97, v97, 0x3e8b97f6, v52
    v_fmamk_f32 v98, v98, 0x3e8b97f6, v52
    v_fmamk_f32 v99, v99, 0x3e8b97f6, v52
    v_fmamk_f32 v100, v100, 0x3e8b97f6, v52
    v_fmamk_f32 v101, v101, 0x3e8b97f6, v52
    v_fmamk_f32 v102, v102, 0x3e8b97f6, v52
    v_fmamk_f32 v103, v103, 0x3e8b97f6, v52
    v_exp_f32 v96, v96
    v_exp_f32 v97, v97
    v_exp_f32 v98, v98
    v_exp_f32 v99, v99
    v_exp_f32 v100, v100
    v_exp_f32 v101, v101
    v_exp_f32 v102, v102
    v_exp_f32 v103, v103
    v_cvt_pk_bf16_f32 v96, v96, v97
    v_cvt_pk_bf16_f32 v97, v98, v99
    v_cvt_pk_bf16_f32 v98, v100, v101
    v_cvt_pk_bf16_f32 v99, v102, v103
    s_waitcnt lgkmcnt(6)
    v_mfma_f32_16x16x32_bf16 v[8:11], v[16:19], v[88:91], v[8:11]
    v_mfma_f32_16x16x32_bf16 v[12:15], v[20:23], v[88:91], v[12:15]
    ds_read_b128 v[16:19], v55 offset:40960
    ds_read_b128 v[20:23], v55 offset:41984
    s_waitcnt lgkmcnt(6)
    v_mfma_f32_16x16x32_bf16 v[8:11], v[24:27], v[96:99], v[8:11]
    v_mfma_f32_16x16x32_bf16 v[12:15], v[28:31], v[96:99], v[12:15]
    v_fmamk_f32 v104, v104, 0x3e8b97f6, v52
    v_fmamk_f32 v105, v105, 0x3e8b97f6, v52
    v_fmamk_f32 v106, v106, 0x3e8b97f6, v52
    v_fmamk_f32 v107, v107, 0x3e8b97f6, v52
    v_fmamk_f32 v108, v108, 0x3e8b97f6, v52
    v_fmamk_f32 v109, v109, 0x3e8b97f6, v52
    v_fmamk_f32 v110, v110, 0x3e8b97f6, v52
    v_fmamk_f32 v111, v111, 0x3e8b97f6, v52
    v_exp_f32 v104, v104
    v_exp_f32 v105, v105
    v_exp_f32 v106, v106
    v_exp_f32 v107, v107
    v_exp_f32 v108, v108
    v_exp_f32 v109, v109
    v_exp_f32 v110, v110
    v_exp_f32 v111, v111
    v_cvt_pk_bf16_f32 v104, v104, v105
    v_cvt_pk_bf16_f32 v105, v106, v107
    v_cvt_pk_bf16_f32 v106, v108, v109
    v_cvt_pk_bf16_f32 v107, v110, v111
    s_waitcnt lgkmcnt(4)
    s_nop 0
    v_mfma_f32_16x16x32_bf16 v[8:11], v[32:35], v[104:107], v[8:11]
    v_mfma_f32_16x16x32_bf16 v[12:15], v[36:39], v[104:107], v[12:15]
    v_fmamk_f32 v112, v112, 0x3e8b97f6, v52
    v_fmamk_f32 v113, v113, 0x3e8b97f6, v52
    v_fmamk_f32 v114, v114, 0x3e8b97f6, v52
    v_fmamk_f32 v115, v115, 0x3e8b97f6, v52
    v_fmamk_f32 v116, v116, 0x3e8b97f6, v52
    v_fmamk_f32 v117, v117, 0x3e8b97f6, v52
    v_fmamk_f32 v118, v118, 0x3e8b97f6, v52
    v_fmamk_f32 v119, v119, 0x3e8b97f6, v52
    v_exp_f32 v112, v112
    v_exp_f32 v113, v113
    v_exp_f32 v114, v114
    v_exp_f32 v115, v115
    v_exp_f32 v116, v116
    v_exp_f32 v117, v117
    v_exp_f32 v118, v118
    v_exp_f32 v119, v119
    v_cvt_pk_bf16_f32 v112, v112, v113
    v_cvt_pk_bf16_f32 v113, v114, v115
    v_cvt_pk_bf16_f32 v114, v116, v117
    v_cvt_pk_bf16_f32 v115, v118, v119
    v_fmamk_f32 v120, v120, 0x3e8b97f6, v52
    v_fmamk_f32 v121, v121, 0x3e8b97f6, v52
    v_fmamk_f32 v122, v122, 0x3e8b97f6, v52
    v_fmamk_f32 v123, v123, 0x3e8b97f6, v52
    v_fmamk_f32 v124, v124, 0x3e8b97f6, v52
    v_fmamk_f32 v125, v125, 0x3e8b97f6, v52
    v_fmamk_f32 v126, v126, 0x3e8b97f6, v52
    v_fmamk_f32 v127, v127, 0x3e8b97f6, v52
    v_exp_f32 v120, v120
    v_exp_f32 v121, v121
    v_exp_f32 v122, v122
    v_exp_f32 v123, v123
    v_exp_f32 v124, v124
    v_exp_f32 v125, v125
    v_exp_f32 v126, v126
    v_exp_f32 v127, v127
    v_cvt_pk_bf16_f32 v120, v120, v121
    v_cvt_pk_bf16_f32 v121, v122, v123
    v_cvt_pk_bf16_f32 v122, v124, v125
    v_cvt_pk_bf16_f32 v123, v126, v127
    s_waitcnt lgkmcnt(2)
    v_mfma_f32_16x16x32_bf16 v[8:11], v[40:43], v[112:115], v[8:11]
    v_mfma_f32_16x16x32_bf16 v[12:15], v[44:47], v[112:115], v[12:15]
    s_waitcnt lgkmcnt(0)
    v_mfma_f32_16x16x32_bf16 v[8:11], v[16:19], v[120:123], v[8:11]
    v_mfma_f32_16x16x32_bf16 v[12:15], v[20:23], v[120:123], v[12:15]
    v_cmp_eq_u32 vcc, 3, v4
    s_nop 6
    v_cndmask_b32 v52, 0, v12, vcc
    v_mov_b32 v53, v52
    s_nop 1
    v_permlane16_swap_b32 v52, v53
    v_add_f32 v52, v52, v53
    v_mov_b32 v53, v52
    s_nop 1
    v_permlane32_swap_b32 v52, v53
    v_add_f32 v52, v52, v53
    v_rcp_f32 v52, v52
    s_nop 0
    v_mul_f32 v8, v8, v52
    v_mul_f32 v9, v9, v52
    v_mul_f32 v10, v10, v52
    v_mul_f32 v11, v11, v52
    v_mul_f32 v12, v12, v52
    v_mul_f32 v13, v13, v52
    v_mul_f32 v14, v14, v52
    v_mul_f32 v15, v15, v52
    v_cvt_pk_bf16_f32 v16, v8, v9
    v_cvt_pk_bf16_f32 v17, v10, v11
    v_cvt_pk_bf16_f32 v18, v12, v13
    v_cvt_pk_bf16_f32 v19, v14, v15
    s_lshl_b32 s12, s67, 4
    s_add_u32 s12, s12, s9
    s_lshl_b32 s12, s12, 10
    s_add_u32 s12, s12, 16777216
    buffer_store_dwordx4 v[16:19], v5, s[60:63], s12 offen  sc1
    s_lshl_b32 s12, s8, 4
    s_add_u32 s12, s12, s9
    s_waitcnt vmcnt(0)
    s_barrier
    s_cmp_lg_u32 s3, 0
    s_cbranch_scc1 m_sig15
    s_lshl_b32 s10, s12, 7
    s_add_u32 s10, s10, 9568256
    v_mov_b32 v10, 0
    v_mov_b32 v8, s56
    v_mov_b32 v9, s57
    s_mov_b64 exec, 1
    s_cmp_lg_u32 s75, 0
    s_cselect_b32 s14, s10, 0x40000000
    s_cselect_b32 s15, 0x40000000, s10
    buffer_store_dwordx2 v[8:9], v10, s[60:63], s14 offen
    buffer_store_dwordx2 v[8:9], v10, s[60:63], s15 offen  sc1
    s_mov_b64 exec, -1
m_sig15:
    s_cmp_eq_u32 s5, 7
    s_cbranch_scc1 m_skipo0
    s_bfe_u32 s64, s3, 0x10001
    s_lshr_b32 s65, s3, 2
    s_lshl_b32 s66, s65, 1
    s_add_u32 s66, s66, s7
    s_xor_b32 s67, s66, 1
    s_lshl_b32 s10, s7, 13
    s_lshl_b32 s11, s66, 14
    s_add_u32 s11, s11, s10
    v_add_u32 v16, s11, v5
    s_lshl_b32 s11, s67, 14
    s_add_u32 s11, s11, s10
    v_add_u32 v17, s11, v5
    v_bfe_u32 v18, v2, 2, 2
    v_lshrrev_b32 v23, 1, v18
    v_xor_b32 v23, s64, v23
    v_lshl_add_u32 v18, v4, 3, v18
    v_lshlrev_b32 v18, 7, v18
    v_lshl_add_u32 v18, v23, 6, v18
    v_and_b32 v23, 3, v2
    v_lshl_add_u32 v18, v23, 4, v18
    s_mul_i32 s11, s7, 28672
    s_add_u32 s11, s11, 65536
    v_add_u32 v18, s11, v18
    v_subrev_u32 v23, 3, v4
    v_ashrrev_i32 v23, 31, v23
    s_lshl_b32 s10, s4, 6
    s_lshl_b32 s11, s66, 4
    s_add_u32 s10, s10, s11
    v_add_u32 v19, s10, v3
    s_movk_i32 s11, 896
    v_mul_lo_u32 v19, v19, s11
    s_lshl_b32 s10, s5, 7
    s_lshl_b32 s11, s64, 6
    s_add_u32 s10, s10, s11
    v_lshl_add_u32 v19, v4, 4, v19
    v_add_u32 v19, s10, v19
    s_lshl_b32 s10, s66, 1
    s_add_u32 s10, s10, s64
    s_lshl_b32 s10, s10, 10
    s_add_u32 s10, s10, 131072
    v_add_u32 v20, s10, v5
    ds_read_b128 v[24:27], v20
    s_lshl_b32 s10, s3, 11
    s_add_u32 s10, s10, 139264
    v_add_u32 v21, s10, v5
    v_xor_b32 v22, 2048, v21
    s_cmp_lg_u32 s3, 0
    s_nop 0
    s_cbranch_scc1 m_wd16
    s_lshr_b32 s10, s4, 1
    s_lshl_b32 s10, s10, 4
    v_add_u32 v8, 0, v2
    v_min_u32 v8, 15, v8
    v_add_u32 v8, s10, v8
    v_max_i32 v8, 0, v8
    v_lshlrev_b32 v8, 7, v8
    s_mov_b32 s10, 9568256
    s_mov_b32 s11, 0
    buffer_load_dwordx2 v[108:109], v8, s[60:63], s10 offen sc1
    s_sleep 2
m_wl16:
    buffer_load_dwordx2 v[112:113], v8, s[60:63], s10 offen sc1
    s_waitcnt vmcnt(1)
    v_xor_b32 v108, s56, v108
    v_xor_b32 v109, s57, v109
    v_lshrrev_b32 v110, 8, v109
    v_or_b32 v110, v110, v108
    v_cmp_ne_u32 vcc, 0, v110
    s_nop 4
    s_cbranch_vccz m_wa16
    buffer_load_dwordx2 v[108:109], v8, s[60:63], s10 offen sc1
    s_waitcnt vmcnt(1)
    v_xor_b32 v112, s56, v112
    v_xor_b32 v113, s57, v113
    v_lshrrev_b32 v114, 8, v113
    v_or_b32 v114, v114, v112
    v_cmp_ne_u32 vcc, 0, v114
    s_nop 4
    s_cbranch_vccz m_wb16
    s_add_u32 s11, s11, 1
    s_cmp_gt_u32 s11, 200000
    s_cbranch_scc0 m_wl16
    s_branch m_wb16
m_wa16:
m_wb16:
m_wd16:
    s_barrier
    s_lshl_b32 s10, s4, 16
    s_lshl_b32 s11, s3, 13
    s_add_u32 s10, s10, s11
    s_add_u32 s10, s10, 16777216
    s_mov_b32 m0, s11
    s_nop 0
    buffer_load_dwordx4 v5, s[60:63], s10 offen offset:0 sc1 lds
    buffer_load_dwordx4 v5, s[60:63], s10 offen offset:1024 sc1 lds
    buffer_load_dwordx4 v5, s[60:63], s10 offen offset:2048 sc1 lds
    buffer_load_dwordx4 v5, s[60:63], s10 offen offset:3072 sc1 lds
    s_add_u32 s10, s10, 4096
    s_add_u32 s11, s11, 4096
    s_mov_b32 m0, s11
    s_nop 0
    buffer_load_dwordx4 v5, s[60:63], s10 offen offset:0 sc1 lds
    buffer_load_dwordx4 v5, s[60:63], s10 offen offset:1024 sc1 lds
    buffer_load_dwordx4 v5, s[60:63], s10 offen offset:2048 sc1 lds
    buffer_load_dwordx4 v5, s[60:63], s10 offen offset:3072 sc1 lds
    ds_read_b64_tr_b16 v[44:45], v18 offset:0
    ds_read_b64_tr_b16 v[46:47], v18 offset:512
    ds_read_b64_tr_b16 v[48:49], v18 offset:8
    ds_read_b64_tr_b16 v[50:51], v18 offset:520
    ds_read_b64_tr_b16 v[52:53], v18 offset:3584
    ds_read_b64_tr_b16 v[54:55], v18 offset:4096
    ds_read_b64_tr_b16 v[56:57], v18 offset:3592
    ds_read_b64_tr_b16 v[58:59], v18 offset:4104
    ds_read_b64_tr_b16 v[60:61], v18 offset:7168
    ds_read_b64_tr_b16 v[62:63], v18 offset:7680
    ds_read_b64_tr_b16 v[64:65], v18 offset:7176
    ds_read_b64_tr_b16 v[66:67], v18 offset:7688
    ds_read_b64_tr_b16 v[68:69], v18 offset:10752
    ds_read_b64_tr_b16 v[70:71], v18 offset:11264
    ds_read_b64_tr_b16 v[72:73], v18 offset:10760
    ds_read_b64_tr_b16 v[74:75], v18 offset:11272
    ds_read_b64_tr_b16 v[76:77], v18 offset:14336
    ds_read_b64_tr_b16 v[78:79], v18 offset:14848
    ds_read_b64_tr_b16 v[80:81], v18 offset:14344
    ds_read_b64_tr_b16 v[82:83], v18 offset:14856
    ds_read_b64_tr_b16 v[84:85], v18 offset:17920
    ds_read_b64_tr_b16 v[86:87], v18 offset:18432
    ds_read_b64_tr_b16 v[88:89], v18 offset:17928
    ds_read_b64_tr_b16 v[90:91], v18 offset:18440
    ds_read_b64_tr_b16 v[92:93], v18 offset:21504
    ds_read_b64_tr_b16 v[94:95], v18 offset:22016
    ds_read_b64_tr_b16 v[96:97], v18 offset:21512
    ds_read_b64_tr_b16 v[98:99], v18 offset:22024
    ds_read_b64_tr_b16 v[100:101], v18 offset:25088
    ds_read_b64_tr_b16 v[102:103], v18 offset:25600
    ds_read_b64_tr_b16 v[104:105], v18 offset:25096
    ds_read_b64_tr_b16 v[106:107], v18 offset:25608
    s_waitcnt lgkmcnt(0)
    v_and_b32 v46, v23, v46
    v_and_b32 v47, v23, v47
    v_and_b32 v50, v23, v50
    v_and_b32 v51, v23, v51
    v_and_b32 v54, v23, v54
    v_and_b32 v55, v23, v55
    v_and_b32 v58, v23, v58
    v_and_b32 v59, v23, v59
    v_and_b32 v62, v23, v62
    v_and_b32 v63, v23, v63
    v_and_b32 v66, v23, v66
    v_and_b32 v67, v23, v67
    v_and_b32 v70, v23, v70
    v_and_b32 v71, v23, v71
    v_and_b32 v74, v23, v74
    v_and_b32 v75, v23, v75
    v_and_b32 v78, v23, v78
    v_and_b32 v79, v23, v79
    v_and_b32 v82, v23, v82
    v_and_b32 v83, v23, v83
    v_and_b32 v86, v23, v86
    v_and_b32 v87, v23, v87
    v_and_b32 v90, v23, v90
    v_and_b32 v91, v23, v91
    v_and_b32 v94, v23, v94
    v_and_b32 v95, v23, v95
    v_and_b32 v98, v23, v98
    v_and_b32 v99, v23, v99
    v_and_b32 v102, v23, v102
    v_and_b32 v103, v23, v103
    v_and_b32 v106, v23, v106
    v_and_b32 v107, v23, v107
    s_waitcnt vmcnt(4)
    s_barrier
    ds_read_b128 v[108:111], v16 offset:0
    ds_read_b128 v[112:115], v17 offset:0
    ds_read_b128 v[116:119], v16 offset:1024
    ds_read_b128 v[120:123], v17 offset:1024
    ds_read_b128 v[124:127], v16 offset:2048
    ds_read_b128 v[128:131], v17 offset:2048
    s_waitcnt lgkmcnt(4)
    v_mfma_f32_16x16x32_bf16 v[28:31], v[44:47], v[108:111], 0
    v_mfma_f32_16x16x32_bf16 v[32:35], v[48:51], v[108:111], 0
    v_mfma_f32_16x16x32_bf16 v[36:39], v[44:47], v[112:115], 0
    v_mfma_f32_16x16x32_bf16 v[40:43], v[48:51], v[112:115], 0
    ds_read_b128 v[108:111], v16 offset:3072
    ds_read_b128 v[112:115], v17 offset:3072
    s_waitcnt lgkmcnt(4)
    v_mfma_f32_16x16x32_bf16 v[28:31], v[52:55], v[116:119], v[28:31]
    v_mfma_f32_16x16x32_bf16 v[32:35], v[56:59], v[116:119], v[32:35]
    v_mfma_f32_16x16x32_bf16 v[36:39], v[52:55], v[120:123], v[36:39]
    v_mfma_f32_16x16x32_bf16 v[40:43], v[56:59], v[120:123], v[40:43]
    s_waitcnt vmcnt(0)
    s_barrier
    ds_read_b128 v[116:119], v16 offset:4096
    ds_read_b128 v[120:123], v17 offset:4096
    s_waitcnt lgkmcnt(4)
    v_mfma_f32_16x16x32_bf16 v[28:31], v[60:63], v[124:127], v[28:31]
    v_mfma_f32_16x16x32_bf16 v[32:35], v[64:67], v[124:127], v[32:35]
    v_mfma_f32_16x16x32_bf16 v[36:39], v[60:63], v[128:131], v[36:39]
    v_mfma_f32_16x16x32_bf16 v[40:43], v[64:67], v[128:131], v[40:43]
    ds_read_b128 v[124:127], v16 offset:5120
    ds_read_b128 v[128:131], v17 offset:5120
    s_waitcnt lgkmcnt(4)
    v_mfma_f32_16x16x32_bf16 v[28:31], v[68:71], v[108:111], v[28:31]
    v_mfma_f32_16x16x32_bf16 v[32:35], v[72:75], v[108:111], v[32:35]
    v_mfma_f32_16x16x32_bf16 v[36:39], v[68:71], v[112:115], v[36:39]
    v_mfma_f32_16x16x32_bf16 v[40:43], v[72:75], v[112:115], v[40:43]
    ds_read_b128 v[108:111], v16 offset:6144
    ds_read_b128 v[112:115], v17 offset:6144
    s_waitcnt lgkmcnt(4)
    v_mfma_f32_16x16x32_bf16 v[28:31], v[76:79], v[116:119], v[28:31]
    v_mfma_f32_16x16x32_bf16 v[32:35], v[80:83], v[116:119], v[32:35]
    v_mfma_f32_16x16x32_bf16 v[36:39], v[76:79], v[120:123], v[36:39]
    v_mfma_f32_16x16x32_bf16 v[40:43], v[80:83], v[120:123], v[40:43]
    ds_read_b128 v[116:119], v16 offset:7168
    ds_read_b128 v[120:123], v17 offset:7168
    s_waitcnt lgkmcnt(4)
    v_mfma_f32_16x16x32_bf16 v[28:31], v[84:87], v[124:127], v[28:31]
    v_mfma_f32_16x16x32_bf16 v[32:35], v[88:91], v[124:127], v[32:35]
    v_mfma_f32_16x16x32_bf16 v[36:39], v[84:87], v[128:131], v[36:39]
    v_mfma_f32_16x16x32_bf16 v[40:43], v[88:91], v[128:131], v[40:43]
    s_waitcnt lgkmcnt(2)
    v_mfma_f32_16x16x32_bf16 v[28:31], v[92:95], v[108:111], v[28:31]
    v_mfma_f32_16x16x32_bf16 v[32:35], v[96:99], v[108:111], v[32:35]
    v_mfma_f32_16x16x32_bf16 v[36:39], v[92:95], v[112:115], v[36:39]
    v_mfma_f32_16x16x32_bf16 v[40:43], v[96:99], v[112:115], v[40:43]
    s_waitcnt lgkmcnt(0)
    v_mfma_f32_16x16x32_bf16 v[28:31], v[100:103], v[116:119], v[28:31]
    v_mfma_f32_16x16x32_bf16 v[32:35], v[104:107], v[116:119], v[32:35]
    v_mfma_f32_16x16x32_bf16 v[36:39], v[100:103], v[120:123], v[36:39]
    v_mfma_f32_16x16x32_bf16 v[40:43], v[104:107], v[120:123], v[40:43]
    s_nop 6
    ds_write_b128 v21, v[36:39] offset:0
    ds_write_b128 v21, v[40:43] offset:1024
    s_waitcnt lgkmcnt(0)
    s_barrier
    ds_read_b128 v[44:47], v22 offset:0
    ds_read_b128 v[48:51], v22 offset:1024
    s_waitcnt lgkmcnt(0)
    v_add_f32 v28, v28, v44
    v_add_f32 v29, v29, v45
    v_add_f32 v30, v30, v46
    v_add_f32 v31, v31, v47
    v_add_f32 v32, v32, v48
    v_add_f32 v33, v33, v49
    v_add_f32 v34, v34, v50
    v_add_f32 v35, v35, v51
    v_cvt_pk_bf16_f32 v52, v28, v29
    v_lshlrev_b32 v28, 16, v52
    v_and_b32 v29, 0xffff0000, v52
    v_lshlrev_b32 v53, 16, v24
    v_and_b32 v54, 0xffff0000, v24
    v_add_f32 v28, v28, v53
    v_add_f32 v29, v29, v54
    v_cvt_pk_bf16_f32 v56, v28, v29
    v_cvt_pk_bf16_f32 v52, v30, v31
    v_lshlrev_b32 v30, 16, v52
    v_and_b32 v31, 0xffff0000, v52
    v_lshlrev_b32 v53, 16, v25
    v_and_b32 v54, 0xffff0000, v25
    v_add_f32 v30, v30, v53
    v_add_f32 v31, v31, v54
    v_cvt_pk_bf16_f32 v57, v30, v31
    v_cvt_pk_bf16_f32 v52, v32, v33
    v_lshlrev_b32 v32, 16, v52
    v_and_b32 v33, 0xffff0000, v52
    v_lshlrev_b32 v53, 16, v26
    v_and_b32 v54, 0xffff0000, v26
    v_add_f32 v32, v32, v53
    v_add_f32 v33, v33, v54
    v_cvt_pk_bf16_f32 v58, v32, v33
    v_cvt_pk_bf16_f32 v52, v34, v35
    v_lshlrev_b32 v34, 16, v52
    v_and_b32 v35, 0xffff0000, v52
    v_lshlrev_b32 v53, 16, v27
    v_and_b32 v54, 0xffff0000, v27
    v_add_f32 v34, v34, v53
    v_add_f32 v35, v35, v54
    v_cvt_pk_bf16_f32 v59, v34, v35
    s_lshl_b32 s10, s4, 2
    s_add_u32 s10, s10, s66
    s_mul_i32 s10, s10, 14
    s_lshl_b32 s11, s5, 1
    s_add_u32 s10, s10, s11
    s_add_u32 s10, s10, s64
    s_lshl_b32 s10, s10, 10
    s_add_u32 s10, s10, 20971520
    buffer_store_dwordx4 v[56:59], v5, s[60:63], s10 offen  sc1
    v_mov_b32 v60, 0
    v_mov_b32 v61, 0
    v_dot2c_f32_bf16 v60, s78, v56
    v_dot2c_f32_bf16 v61, v56, v56
    v_dot2c_f32_bf16 v60, s78, v57
    v_dot2c_f32_bf16 v61, v57, v57
    v_dot2c_f32_bf16 v60, s78, v58
    v_dot2c_f32_bf16 v61, v58, v58
    v_dot2c_f32_bf16 v60, s78, v59
    v_dot2c_f32_bf16 v61, v59, v59
    s_nop 1
    v_mov_b32 v62, v60
    s_nop 1
    v_permlane16_swap_b32 v60, v62
    v_add_f32 v60, v60, v62
    v_mov_b32 v62, v60
    s_nop 1
    v_permlane32_swap_b32 v60, v62
    v_add_f32 v60, v60, v62
    v_mov_b32 v63, v61
    s_nop 1
    v_permlane16_swap_b32 v61, v63
    v_add_f32 v61, v61, v63
    v_mov_b32 v63, v61
    s_nop 1
    v_permlane32_swap_b32 v61, v63
    v_add_f32 v61, v61, v63
    s_lshl_b32 s10, s4, 2
    s_add_u32 s10, s10, s66
    s_mul_i32 s10, s10, 1792
    s_lshl_b32 s11, s5, 1
    s_add_u32 s11, s11, s64
    s_lshl_b32 s11, s11, 7
    s_add_u32 s10, s10, s11
    s_add_u32 s10, s10, 23068672
    v_lshlrev_b32 v62, 3, v3
    s_mov_b64 exec, 0xffff
    buffer_store_dwordx2 v[60:61], v62, s[60:63], s10 offen sc1
    s_mov_b64 exec, -1
    s_lshl_b32 s12, s4, 3
    s_add_u32 s12, s12, s5
    s_waitcnt vmcnt(0)
    s_barrier
    s_cmp_lg_u32 s3, 0
    s_cbranch_scc1 m_sig17
    s_lshl_b32 s10, s12, 7
    s_add_u32 s10, s10, 9601024
    v_mov_b32 v10, 0
    v_mov_b32 v8, s56
    v_mov_b32 v9, s57
    s_mov_b64 exec, 1
    s_cmp_lg_u32 s75, 0
    s_cselect_b32 s14, s10, 0x40000000
    s_cselect_b32 s15, 0x40000000, s10
    buffer_store_dwordx2 v[8:9], v10, s[60:63], s14 offen
    buffer_store_dwordx2 v[8:9], v10, s[60:63], s15 offen  sc1
    s_mov_b64 exec, -1
m_sig17:
m_skipo0:
    v_accvgpr_read_b32 v88, a84
    v_accvgpr_read_b32 v89, a85
    v_accvgpr_read_b32 v90, a86
    v_accvgpr_read_b32 v91, a87
    v_lshlrev_b32 v16, 16, v88
    v_and_b32 v17, 0xffff0000, v88
    v_lshlrev_b32 v18, 16, v89
    v_and_b32 v19, 0xffff0000, v89
    v_lshlrev_b32 v20, 16, v90
    v_and_b32 v21, 0xffff0000, v90
    v_lshlrev_b32 v22, 16, v91
    v_and_b32 v23, 0xffff0000, v91
    v_accvgpr_read_b32 v88, a88
    v_accvgpr_read_b32 v89, a89
    v_accvgpr_read_b32 v90, a90
    v_accvgpr_read_b32 v91, a91
    v_lshlrev_b32 v24, 16, v88
    v_and_b32 v25, 0xffff0000, v88
    v_lshlrev_b32 v26, 16, v89
    v_and_b32 v27, 0xffff0000, v89
    v_lshlrev_b32 v28, 16, v90
    v_and_b32 v29, 0xffff0000, v90
    v_lshlrev_b32 v30, 16, v91
    v_and_b32 v31, 0xffff0000, v91
    v_accvgpr_read_b32 v88, a92
    v_accvgpr_read_b32 v89, a93
    v_accvgpr_read_b32 v90, a94
    v_accvgpr_read_b32 v91, a95
    v_lshlrev_b32 v32, 16, v88
    v_and_b32 v33, 0xffff0000, v88
    v_lshlrev_b32 v34, 16, v89
    v_and_b32 v35, 0xffff0000, v89
    v_lshlrev_b32 v36, 16, v90
    v_and_b32 v37, 0xffff0000, v90
    v_lshlrev_b32 v38, 16, v91
    v_and_b32 v39, 0xffff0000, v91
    v_accvgpr_read_b32 v88, a96
    v_accvgpr_read_b32 v89, a97
    v_accvgpr_read_b32 v90, a98
    v_accvgpr_read_b32 v91, a99
    v_lshlrev_b32 v40, 16, v88
    v_and_b32 v41, 0xffff0000, v88
    v_lshlrev_b32 v42, 16, v89
    v_and_b32 v43, 0xffff0000, v89
    v_lshlrev_b32 v44, 16, v90
    v_and_b32 v45, 0xffff0000, v90
    v_lshlrev_b32 v46, 16, v91
    v_and_b32 v47, 0xffff0000, v91
    v_accvgpr_read_b32 v88, a100
    v_accvgpr_read_b32 v89, a101
    v_accvgpr_read_b32 v90, a102
    v_accvgpr_read_b32 v91, a103
    v_lshlrev_b32 v48, 16, v88
    v_and_b32 v49, 0xffff0000, v88
    v_lshlrev_b32 v50, 16, v89
    v_and_b32 v51, 0xffff0000, v89
    v_lshlrev_b32 v52, 16, v90
    v_and_b32 v53, 0xffff0000, v90
    v_lshlrev_b32 v54, 16, v91
    v_and_b32 v55, 0xffff0000, v91
    v_accvgpr_read_b32 v88, a104
    v_accvgpr_read_b32 v89, a105
    v_accvgpr_read_b32 v90, a106
    v_accvgpr_read_b32 v91, a107
    v_lshlrev_b32 v56, 16, v88
    v_and_b32 v57, 0xffff0000, v88
    v_lshlrev_b32 v58, 16, v89
    v_and_b32 v59, 0xffff0000, v89
    v_lshlrev_b32 v60, 16, v90
    v_and_b32 v61, 0xffff0000, v90
    v_lshlrev_b32 v62, 16, v91
    v_and_b32 v63, 0xffff0000, v91
    v_accvgpr_read_b32 v88, a108
    v_accvgpr_read_b32 v89, a109
    v_accvgpr_read_b32 v90, a110
    v_accvgpr_read_b32 v91, a111
    v_lshlrev_b32 v64, 16, v88
    v_and_b32 v65, 0xffff0000, v88
    v_lshlrev_b32 v66, 16, v89
    v_and_b32 v67, 0xffff0000, v89
    v_lshlrev_b32 v68, 16, v90
    v_and_b32 v69, 0xffff0000, v90
    v_lshlrev_b32 v70, 16, v91
    v_and_b32 v71, 0xffff0000, v91
    v_mov_b32 v72, s78
    v_mov_b32 v73, s78
    v_mov_b32 v74, s78
    v_mov_b32 v75, s78
    s_lshl_b32 s10, s4, 2
    s_add_u32 s10, s10, s6
    s_mul_i32 s64, s10, 1792
    s_add_u32 s64, s64, 23068672
    s_mul_i32 s65, s10, 14336
    s_mul_i32 s11, s7, 7168
    s_add_u32 s65, s65, s11
    s_add_u32 s65, s65, 20971520
    s_add_u32 s66, s65, 4096
    v_lshlrev_b32 v128, 3, v2
    v_lshrrev_b32 v130, 5, v2
    v_lshl_or_b32 v129, v130, 30, v128
    s_cmp_lg_u32 s3, 0
    s_nop 0
    s_cbranch_scc1 m_wd18
    s_lshl_b32 s10, s4, 3
    v_add_u32 v8, 0, v2
    v_min_u32 v8, 6, v8
    v_add_u32 v8, s10, v8
    v_max_i32 v8, 0, v8
    v_lshlrev_b32 v8, 7, v8
    s_mov_b32 s10, 9601024
    s_mov_b32 s11, 0
    buffer_load_dwordx2 v[96:97], v8, s[60:63], s10 offen sc1
    s_sleep 2
m_wl18:
    buffer_load_dwordx2 v[100:101], v8, s[60:63], s10 offen sc1
    s_waitcnt vmcnt(1)
    v_xor_b32 v96, s56, v96
    v_xor_b32 v97, s57, v97
    v_lshrrev_b32 v98, 8, v97
    v_or_b32 v98, v98, v96
    v_cmp_ne_u32 vcc, 0, v98
    s_nop 4
    s_cbranch_vccz m_wa18
    buffer_load_dwordx2 v[96:97], v8, s[60:63], s10 offen sc1
    s_waitcnt vmcnt(1)
    v_xor_b32 v100, s56, v100
    v_xor_b32 v101, s57, v101
    v_lshrrev_b32 v102, 8, v101
    v_or_b32 v102, v102, v100
    v_cmp_ne_u32 vcc, 0, v102
    s_nop 4
    s_cbranch_vccz m_wb18
    s_add_u32 s11, s11, 1
    s_cmp_gt_u32 s11, 200000
    s_cbranch_scc0 m_wl18
    s_branch m_wb18
m_wa18:
m_wb18:
m_wd18:
    s_barrier
    buffer_load_dwordx2 v[88:89], v128, s[60:63], s64 offen offset:0 sc1
    buffer_load_dwordx2 v[90:91], v128, s[60:63], s64 offen offset:512 sc1
    buffer_load_dwordx2 v[92:93], v128, s[60:63], s64 offen offset:1024 sc1
    buffer_load_dwordx2 v[94:95], v129, s[60:63], s64 offen offset:1536 sc1
    buffer_load_dwordx4 v[96:99], v5, s[60:63], s65 offen offset:0 sc1
    buffer_load_dwordx4 v[100:103], v5, s[60:63], s65 offen offset:1024 sc1
    buffer_load_dwordx4 v[104:107], v5, s[60:63], s65 offen offset:2048 sc1
    buffer_load_dwordx4 v[108:111], v5, s[60:63], s65 offen offset:3072 sc1
    buffer_load_dwordx4 v[112:115], v5, s[60:63], s66 offen offset:0 sc1
    buffer_load_dwordx4 v[116:119], v5, s[60:63], s66 offen offset:1024 sc1
    buffer_load_dwordx4 v[120:123], v5, s[60:63], s66 offen offset:2048 sc1
    s_lshl_b32 s10, s3, 10
    s_add_u32 s10, s10, 139264
    v_add_u32 v14, s10, v5
    v_lshrrev_b32 v11, 2, v3
    v_lshl_add_u32 v11, v11, 4, v3
    v_lshlrev_b32 v11, 4, v11
    v_and_b32 v12, 3, v3
    v_lshl_add_u32 v11, v12, 2, v11
    v_add_u32 v11, s10, v11
    v_xor_b32 v12, 1024, v11
    s_lshl_b32 s10, s3, 8
    s_add_u32 s10, s10, 147456
    v_lshl_add_u32 v15, v3, 2, s10
    v_xor_b32 v13, 256, v15
    s_mul_i32 s10, s6, 14336
    s_mul_i32 s11, s7, 7168
    s_add_u32 s10, s10, s11
    v_add_u32 v10, s10, v5
    s_waitcnt vmcnt(7)
    v_add_f32 v88, v88, v90
    v_add_f32 v89, v89, v91
    v_add_f32 v92, v92, v94
    v_add_f32 v93, v93, v95
    v_add_f32 v88, v88, v92
    v_add_f32 v89, v89, v93
    v_mov_b32 v90, v88
    s_nop 1
    v_permlane16_swap_b32 v88, v90
    v_add_f32 v88, v88, v90
    v_mov_b32 v90, v88
    s_nop 1
    v_permlane32_swap_b32 v88, v90
    v_add_f32 v88, v88, v90
    v_mov_b32 v91, v89
    s_nop 1
    v_permlane16_swap_b32 v89, v91
    v_add_f32 v89, v89, v91
    v_mov_b32 v91, v89
    s_nop 1
    v_permlane32_swap_b32 v89, v91
    v_add_f32 v89, v89, v91
    v_mul_f32 v88, s76, v88
    v_mul_f32 v89, s76, v89
    v_fma_f32 v89, -v88, v88, v89
    v_max_f32 v89, 0, v89
    v_cvt_pk_bf16_f32 v90, v88, v89
    v_lshlrev_b32 v88, 16, v90
    v_and_b32 v89, 0xffff0000, v90
    v_add_f32 v89, s77, v89
    v_cvt_pk_bf16_f32 v90, v88, v89
    v_lshlrev_b32 v88, 16, v90
    v_and_b32 v89, 0xffff0000, v90
    v_sqrt_f32 v89, v89
    s_nop 0
    v_cvt_pk_bf16_f32 v90, v88, v89
    v_lshlrev_b32 v88, 16, v90
    v_and_b32 v89, 0xffff0000, v90
    v_rcp_f32 v84, v89
    s_nop 0
    v_mul_f32 v86, -v88, v84
    v_mov_b32 v85, v84
    v_mov_b32 v87, v86
    s_waitcnt vmcnt(6)
    v_lshlrev_b32 v88, 16, v96
    v_and_b32 v89, 0xffff0000, v96
    v_lshlrev_b32 v90, 16, v97
    v_and_b32 v91, 0xffff0000, v97
    v_lshlrev_b32 v92, 16, v98
    v_and_b32 v93, 0xffff0000, v98
    v_lshlrev_b32 v94, 16, v99
    v_and_b32 v95, 0xffff0000, v99
    v_pk_fma_f32 v[124:125], v[88:89], v[84:85], v[86:87]
    v_pk_fma_f32 v[126:127], v[90:91], v[84:85], v[86:87]
    v_pk_fma_f32 v[128:129], v[92:93], v[84:85], v[86:87]
    v_pk_fma_f32 v[130:131], v[94:95], v[84:85], v[86:87]
    v_pk_fma_f32 v[124:125], v[124:125], v[16:17], v[88:89]
    v_pk_fma_f32 v[126:127], v[126:127], v[18:19], v[90:91]
    v_pk_fma_f32 v[128:129], v[128:129], v[20:21], v[92:93]
    v_pk_fma_f32 v[130:131], v[130:131], v[22:23], v[94:95]
    v_cvt_pk_bf16_f32 v96, v124, v125
    v_cvt_pk_bf16_f32 v97, v126, v127
    v_cvt_pk_bf16_f32 v98, v128, v129
    v_cvt_pk_bf16_f32 v99, v130, v131
    ds_write_b128 v10, v[96:99] offset:0
    s_nop 0
    v_mfma_f32_16x16x32_bf16 v[76:79], v[72:75], v[96:99], 0
    v_mfma_f32_16x16x32_bf16 v[80:83], v[96:99], v[96:99], 0
    s_waitcnt vmcnt(5)
    v_lshlrev_b32 v88, 16, v100
    v_and_b32 v89, 0xffff0000, v100
    v_lshlrev_b32 v90, 16, v101
    v_and_b32 v91, 0xffff0000, v101
    v_lshlrev_b32 v92, 16, v102
    v_and_b32 v93, 0xffff0000, v102
    v_lshlrev_b32 v94, 16, v103
    v_and_b32 v95, 0xffff0000, v103
    v_pk_fma_f32 v[124:125], v[88:89], v[84:85], v[86:87]
    v_pk_fma_f32 v[126:127], v[90:91], v[84:85], v[86:87]
    v_pk_fma_f32 v[128:129], v[92:93], v[84:85], v[86:87]
    v_pk_fma_f32 v[130:131], v[94:95], v[84:85], v[86:87]
    v_pk_fma_f32 v[124:125], v[124:125], v[24:25], v[88:89]
    v_pk_fma_f32 v[126:127], v[126:127], v[26:27], v[90:91]
    v_pk_fma_f32 v[128:129], v[128:129], v[28:29], v[92:93]
    v_pk_fma_f32 v[130:131], v[130:131], v[30:31], v[94:95]
    v_cvt_pk_bf16_f32 v100, v124, v125
    v_cvt_pk_bf16_f32 v101, v126, v127
    v_cvt_pk_bf16_f32 v102, v128, v129
    v_cvt_pk_bf16_f32 v103, v130, v131
    ds_write_b128 v10, v[100:103] offset:1024
    s_nop 0
    v_mfma_f32_16x16x32_bf16 v[76:79], v[72:75], v[100:103], v[76:79]
    v_mfma_f32_16x16x32_bf16 v[80:83], v[100:103], v[100:103], v[80:83]
    s_waitcnt vmcnt(4)
    v_lshlrev_b32 v88, 16, v104
    v_and_b32 v89, 0xffff0000, v104
    v_lshlrev_b32 v90, 16, v105
    v_and_b32 v91, 0xffff0000, v105
    v_lshlrev_b32 v92, 16, v106
    v_and_b32 v93, 0xffff0000, v106
    v_lshlrev_b32 v94, 16, v107
    v_and_b32 v95, 0xffff0000, v107
    v_pk_fma_f32 v[124:125], v[88:89], v[84:85], v[86:87]
    v_pk_fma_f32 v[126:127], v[90:91], v[84:85], v[86:87]
    v_pk_fma_f32 v[128:129], v[92:93], v[84:85], v[86:87]
    v_pk_fma_f32 v[130:131], v[94:95], v[84:85], v[86:87]
    v_pk_fma_f32 v[124:125], v[124:125], v[32:33], v[88:89]
    v_pk_fma_f32 v[126:127], v[126:127], v[34:35], v[90:91]
    v_pk_fma_f32 v[128:129], v[128:129], v[36:37], v[92:93]
    v_pk_fma_f32 v[130:131], v[130:131], v[38:39], v[94:95]
    v_cvt_pk_bf16_f32 v104, v124, v125
    v_cvt_pk_bf16_f32 v105, v126, v127
    v_cvt_pk_bf16_f32 v106, v128, v129
    v_cvt_pk_bf16_f32 v107, v130, v131
    ds_write_b128 v10, v[104:107] offset:2048
    s_nop 0
    v_mfma_f32_16x16x32_bf16 v[76:79], v[72:75], v[104:107], v[76:79]
    v_mfma_f32_16x16x32_bf16 v[80:83], v[104:107], v[104:107], v[80:83]
    s_waitcnt vmcnt(3)
    v_lshlrev_b32 v88, 16, v108
    v_and_b32 v89, 0xffff0000, v108
    v_lshlrev_b32 v90, 16, v109
    v_and_b32 v91, 0xffff0000, v109
    v_lshlrev_b32 v92, 16, v110
    v_and_b32 v93, 0xffff0000, v110
    v_lshlrev_b32 v94, 16, v111
    v_and_b32 v95, 0xffff0000, v111
    v_pk_fma_f32 v[124:125], v[88:89], v[84:85], v[86:87]
    v_pk_fma_f32 v[126:127], v[90:91], v[84:85], v[86:87]
    v_pk_fma_f32 v[128:129], v[92:93], v[84:85], v[86:87]
    v_pk_fma_f32 v[130:131], v[94:95], v[84:85], v[86:87]
    v_pk_fma_f32 v[124:125], v[124:125], v[40:41], v[88:89]
    v_pk_fma_f32 v[126:127], v[126:127], v[42:43], v[90:91]
    v_pk_fma_f32 v[128:129], v[128:129], v[44:45], v[92:93]
    v_pk_fma_f32 v[130:131], v[130:131], v[46:47], v[94:95]
    v_cvt_pk_bf16_f32 v108, v124, v125
    v_cvt_pk_bf16_f32 v109, v126, v127
    v_cvt_pk_bf16_f32 v110, v128, v129
    v_cvt_pk_bf16_f32 v111, v130, v131
    ds_write_b128 v10, v[108:111] offset:3072
    s_nop 0
    v_mfma_f32_16x16x32_bf16 v[76:79], v[72:75], v[108:111], v[76:79]
    v_mfma_f32_16x16x32_bf16 v[80:83], v[108:111], v[108:111], v[80:83]
    s_waitcnt vmcnt(2)
    v_lshlrev_b32 v88, 16, v112
    v_and_b32 v89, 0xffff0000, v112
    v_lshlrev_b32 v90, 16, v113
    v_and_b32 v91, 0xffff0000, v113
    v_lshlrev_b32 v92, 16, v114
    v_and_b32 v93, 0xffff0000, v114
    v_lshlrev_b32 v94, 16, v115
    v_and_b32 v95, 0xffff0000, v115
    v_pk_fma_f32 v[124:125], v[88:89], v[84:85], v[86:87]
    v_pk_fma_f32 v[126:127], v[90:91], v[84:85], v[86:87]
    v_pk_fma_f32 v[128:129], v[92:93], v[84:85], v[86:87]
    v_pk_fma_f32 v[130:131], v[94:95], v[84:85], v[86:87]
    v_pk_fma_f32 v[124:125], v[124:125], v[48:49], v[88:89]
    v_pk_fma_f32 v[126:127], v[126:127], v[50:51], v[90:91]
    v_pk_fma_f32 v[128:129], v[128:129], v[52:53], v[92:93]
    v_pk_fma_f32 v[130:131], v[130:131], v[54:55], v[94:95]
    v_cvt_pk_bf16_f32 v112, v124, v125
    v_cvt_pk_bf16_f32 v113, v126, v127
    v_cvt_pk_bf16_f32 v114, v128, v129
    v_cvt_pk_bf16_f32 v115, v130, v131
    ds_write_b128 v10, v[112:115] offset:4096
    s_nop 0
    v_mfma_f32_16x16x32_bf16 v[76:79], v[72:75], v[112:115], v[76:79]
    v_mfma_f32_16x16x32_bf16 v[80:83], v[112:115], v[112:115], v[80:83]
    s_waitcnt vmcnt(1)
    v_lshlrev_b32 v88, 16, v116
    v_and_b32 v89, 0xffff0000, v116
    v_lshlrev_b32 v90, 16, v117
    v_and_b32 v91, 0xffff0000, v117
    v_lshlrev_b32 v92, 16, v118
    v_and_b32 v93, 0xffff0000, v118
    v_lshlrev_b32 v94, 16, v119
    v_and_b32 v95, 0xffff0000, v119
    v_pk_fma_f32 v[124:125], v[88:89], v[84:85], v[86:87]
    v_pk_fma_f32 v[126:127], v[90:91], v[84:85], v[86:87]
    v_pk_fma_f32 v[128:129], v[92:93], v[84:85], v[86:87]
    v_pk_fma_f32 v[130:131], v[94:95], v[84:85], v[86:87]
    v_pk_fma_f32 v[124:125], v[124:125], v[56:57], v[88:89]
    v_pk_fma_f32 v[126:127], v[126:127], v[58:59], v[90:91]
    v_pk_fma_f32 v[128:129], v[128:129], v[60:61], v[92:93]
    v_pk_fma_f32 v[130:131], v[130:131], v[62:63], v[94:95]
    v_cvt_pk_bf16_f32 v116, v124, v125
    v_cvt_pk_bf16_f32 v117, v126, v127
    v_cvt_pk_bf16_f32 v118, v128, v129
    v_cvt_pk_bf16_f32 v119, v130, v131
    ds_write_b128 v10, v[116:119] offset:5120
    s_nop 0
    v_mfma_f32_16x16x32_bf16 v[76:79], v[72:75], v[116:119], v[76:79]
    v_mfma_f32_16x16x32_bf16 v[80:83], v[116:119], v[116:119], v[80:83]
    s_waitcnt vmcnt(0)
    v_lshlrev_b32 v88, 16, v120
    v_and_b32 v89, 0xffff0000, v120
    v_lshlrev_b32 v90, 16, v121
    v_and_b32 v91, 0xffff0000, v121
    v_lshlrev_b32 v92, 16, v122
    v_and_b32 v93, 0xffff0000, v122
    v_lshlrev_b32 v94, 16, v123
    v_and_b32 v95, 0xffff0000, v123
    v_pk_fma_f32 v[124:125], v[88:89], v[84:85], v[86:87]
    v_pk_fma_f32 v[126:127], v[90:91], v[84:85], v[86:87]
    v_pk_fma_f32 v[128:129], v[92:93], v[84:85], v[86:87]
    v_pk_fma_f32 v[130:131], v[94:95], v[84:85], v[86:87]
    v_pk_fma_f32 v[124:125], v[124:125], v[64:65], v[88:89]
    v_pk_fma_f32 v[126:127], v[126:127], v[66:67], v[90:91]
    v_pk_fma_f32 v[128:129], v[128:129], v[68:69], v[92:93]
    v_pk_fma_f32 v[130:131], v[130:131], v[70:71], v[94:95]
    v_cvt_pk_bf16_f32 v120, v124, v125
    v_cvt_pk_bf16_f32 v121, v126, v127
    v_cvt_pk_bf16_f32 v122, v128, v129
    v_cvt_pk_bf16_f32 v123, v130, v131
    ds_write_b128 v10, v[120:123] offset:6144
    s_nop 0
    v_mfma_f32_16x16x32_bf16 v[76:79], v[72:75], v[120:123], v[76:79]
    v_mfma_f32_16x16x32_bf16 v[80:83], v[120:123], v[120:123], v[80:83]
    s_nop 7
    ds_write_b128 v14, v[80:83] offset:10240
    ds_write_b32 v15, v76 offset:10240
    s_mul_i32 s10, s7, 35840
    v_add_u32 v8, s10, v5
    s_mul_i32 s10, s7, -21504
    s_add_u32 s10, s10, 28672
    v_add_u32 v9, s10, v5
    s_mul_i32 s10, s6, 14336
    s_lshl_b32 s11, s5, 11
    s_add_u32 s10, s10, s11
    s_lshl_b32 s11, s7, 10
    s_add_u32 s10, s10, s11
    v_add_u32 v10, s10, v5
    v_mov_b32 v100, v76
    s_waitcnt lgkmcnt(0)
    s_barrier
    ds_read_b128 v[64:67], v9 offset:0
    ds_read_b128 v[68:71], v9 offset:14336
    ds_read_b128 v[72:75], v9 offset:1024
    ds_read_b128 v[76:79], v9 offset:15360
    ds_read_b128 v[112:115], v10
    ds_read_b32 v96, v11 offset:10240
    ds_read_b32 v97, v12 offset:10240
    ds_read_b32 v98, v13 offset:10240
    ds_read_b128 v[80:83], v9 offset:2048
    ds_read_b128 v[84:87], v9 offset:16384
    ds_read_b128 v[88:91], v9 offset:3072
    ds_read_b128 v[92:95], v9 offset:17408
    s_waitcnt lgkmcnt(11)
    v_mfma_f32_16x16x32_bf16 v[40:43], a[0:3], v[64:67], 0
    s_mul_i32 s10, s3, 6144
    s_add_u32 s10, s10, 65536
    v_mfma_f32_16x16x32_bf16 v[44:47], a[4:7], v[64:67], 0
    v_add_u32 v10, s10, v5
    s_xor_b32 s11, s3, 1
    v_mfma_f32_16x16x32_bf16 v[48:51], v[64:67], a[8:11], 0
    s_mul_i32 s11, s11, 6144
    s_add_u32 s11, s11, 65536
    ds_read_b128 v[64:67], v9 offset:4096
    s_waitcnt lgkmcnt(11)
    v_mfma_f32_16x16x32_bf16 v[52:55], a[0:3], v[68:71], 0
    v_add_u32 v11, s11, v5
    s_waitcnt lgkmcnt(5)
    v_mfma_f32_16x16x32_bf16 v[56:59], a[4:7], v[68:71], 0
    v_add_f32 v96, v96, v97
    v_add_f32 v100, v100, v98
    v_mfma_f32_16x16x32_bf16 v[60:63], v[68:71], a[8:11], 0
    v_mul_f32 v100, s76, v100
    v_mul_f32 v96, s76, v96
    ds_read_b128 v[68:71], v9 offset:18432
    v_mfma_f32_16x16x32_bf16 v[40:43], a[12:15], v[72:75], v[40:43]
    v_fma_f32 v96, -v100, v100, v96
    v_max_f32 v96, 0, v96
    v_mfma_f32_16x16x32_bf16 v[44:47], a[16:19], v[72:75], v[44:47]
    v_cvt_pk_bf16_f32 v97, v100, v96
    v_lshlrev_b32 v100, 16, v97
    v_mfma_f32_16x16x32_bf16 v[48:51], v[72:75], a[20:23], v[48:51]
    v_and_b32 v96, 0xffff0000, v97
    v_add_f32 v96, s77, v96
    ds_read_b128 v[72:75], v9 offset:5120
    v_mfma_f32_16x16x32_bf16 v[52:55], a[12:15], v[76:79], v[52:55]
    v_cvt_pk_bf16_f32 v97, v100, v96
    v_lshlrev_b32 v100, 16, v97
    v_mfma_f32_16x16x32_bf16 v[56:59], a[16:19], v[76:79], v[56:59]
    v_and_b32 v96, 0xffff0000, v97
    v_sqrt_f32 v96, v96
    v_mfma_f32_16x16x32_bf16 v[60:63], v[76:79], a[20:23], v[60:63]
    v_cvt_pk_bf16_f32 v97, v100, v96
    v_lshlrev_b32 v100, 16, v97
    ds_read_b128 v[76:79], v9 offset:19456
    s_waitcnt lgkmcnt(7)
    v_mfma_f32_16x16x32_bf16 v[40:43], a[24:27], v[80:83], v[40:43]
    v_and_b32 v96, 0xffff0000, v97
    v_rcp_f32 v101, v96
    v_mfma_f32_16x16x32_bf16 v[44:47], a[28:31], v[80:83], v[44:47]
    v_mul_f32 v102, -v100, v101
    s_lshl_b32 s10, s6, 6
    v_mfma_f32_16x16x32_bf16 v[48:51], v[80:83], a[32:35], v[48:51]
    s_add_u32 s10, s10, 159744
    v_lshl_add_u32 v103, v3, 2, s10
    ds_read_b128 v[80:83], v9 offset:6144
    s_waitcnt lgkmcnt(7)
    v_mfma_f32_16x16x32_bf16 v[52:55], a[24:27], v[84:87], v[52:55]
    ds_write_b32 v103, v101
    ds_write_b32 v103, v102 offset:256
    v_mfma_f32_16x16x32_bf16 v[56:59], a[28:31], v[84:87], v[56:59]
    s_lshl_b32 s10, s3, 10
    s_add_u32 s10, s10, 131072
    v_mfma_f32_16x16x32_bf16 v[60:63], v[84:87], a[32:35], v[60:63]
    v_add_u32 v104, s10, v5
    ds_write_b128 v104, v[112:115]
    ds_read_b128 v[84:87], v9 offset:20480
    s_waitcnt lgkmcnt(10)
    v_mfma_f32_16x16x32_bf16 v[40:43], a[36:39], v[88:91], v[40:43]
    s_lshl_b32 s13, s5, 2
    s_add_u32 s13, s13, s6
    v_mfma_f32_16x16x32_bf16 v[44:47], a[40:43], v[88:91], v[44:47]
    s_lshl_b32 s64, s13, 17
    s_lshl_b32 s65, s4, 12
    v_mfma_f32_16x16x32_bf16 v[48:51], v[88:91], a[44:47], v[48:51]
    s_add_u32 s64, s64, s65
    s_lshl_b32 s65, s7, 11
    ds_read_b128 v[88:91], v8 offset:0
    s_waitcnt lgkmcnt(10)
    v_mfma_f32_16x16x32_bf16 v[52:55], a[36:39], v[92:95], v[52:55]
    s_add_u32 s64, s64, s65
    s_add_u32 s64, s64, 25165824
    v_mfma_f32_16x16x32_bf16 v[56:59], a[40:43], v[92:95], v[56:59]
    s_lshl_b32 s65, s5, 1
    s_lshr_b32 s66, s6, 1
    v_mfma_f32_16x16x32_bf16 v[60:63], v[92:95], a[44:47], v[60:63]
    s_add_u32 s65, s65, s66
    s_lshl_b32 s65, s65, 6
    ds_read_b128 v[92:95], v8 offset:1024
    s_waitcnt lgkmcnt(10)
    v_mfma_f32_16x16x32_bf16 v[40:43], a[48:51], v[64:67], v[40:43]
    s_lshl_b32 s66, s4, 1
    s_add_u32 s65, s65, s66
    v_mfma_f32_16x16x32_bf16 v[44:47], a[52:55], v[64:67], v[44:47]
    s_add_u32 s65, s65, s7
    s_lshl_b32 s65, s65, 1
    v_mfma_f32_16x16x32_bf16 v[48:51], v[64:67], a[56:59], v[48:51]
    s_and_b32 s66, s6, 1
    s_add_u32 s65, s65, s66
    ds_read_b128 v[64:67], v8 offset:2048
    s_waitcnt lgkmcnt(10)
    v_mfma_f32_16x16x32_bf16 v[52:55], a[48:51], v[68:71], v[52:55]
    s_lshl_b32 s65, s65, 10
    s_add_u32 s65, s65, 29360128
    v_mfma_f32_16x16x32_bf16 v[56:59], a[52:55], v[68:71], v[56:59]
    s_lshl_b32 s66, s66, 4
    s_sub_u32 s66, 28, s66
    v_mfma_f32_16x16x32_bf16 v[60:63], v[68:71], a[56:59], v[60:63]
    v_cmp_eq_u32 vcc, s66, v3
    v_mov_b32 v14, s78
    ds_read_b128 v[68:71], v8 offset:3072
    s_waitcnt lgkmcnt(10)
    v_mfma_f32_16x16x32_bf16 v[40:43], a[60:63], v[72:75], v[40:43]
    s_lshl_b32 s10, s7, 7
    s_add_u32 s10, s10, 159744
    v_mfma_f32_16x16x32_bf16 v[44:47], a[64:67], v[72:75], v[44:47]
    v_lshl_add_u32 v12, v3, 2, s10
    v_lshl_add_u32 v13, v4, 4, s10
    v_mfma_f32_16x16x32_bf16 v[48:51], v[72:75], a[68:71], v[48:51]
    ds_read_b128 v[72:75], v8 offset:4096
    s_waitcnt lgkmcnt(10)
    v_mfma_f32_16x16x32_bf16 v[52:55], a[60:63], v[76:79], v[52:55]
    v_mfma_f32_16x16x32_bf16 v[56:59], a[64:67], v[76:79], v[56:59]
    v_mfma_f32_16x16x32_bf16 v[60:63], v[76:79], a[68:71], v[60:63]
    ds_read_b128 v[76:79], v8 offset:5120
    s_waitcnt lgkmcnt(10)
    v_mfma_f32_16x16x32_bf16 v[40:43], a[72:75], v[80:83], v[40:43]
    v_mfma_f32_16x16x32_bf16 v[44:47], a[76:79], v[80:83], v[44:47]
    v_mfma_f32_16x16x32_bf16 v[48:51], v[80:83], a[80:83], v[48:51]
    ds_read_b128 v[80:83], v8 offset:6144
    s_waitcnt lgkmcnt(7)
    v_mfma_f32_16x16x32_bf16 v[52:55], a[72:75], v[84:87], v[52:55]
    v_mfma_f32_16x16x32_bf16 v[56:59], a[76:79], v[84:87], v[56:59]
    v_mfma_f32_16x16x32_bf16 v[60:63], v[84:87], a[80:83], v[60:63]
    ds_read_b128 v[84:87], v8 offset:14336
    s_waitcnt lgkmcnt(7)
    v_mfma_f32_16x16x32_bf16 v[16:19], a[0:3], v[88:91], 0
    v_mfma_f32_16x16x32_bf16 v[20:23], a[4:7], v[88:91], 0
    v_mfma_f32_16x16x32_bf16 v[24:27], v[88:91], a[8:11], 0
    ds_read_b128 v[88:91], v8 offset:15360
    ds_write_b128 v10, v[40:43] offset:0
    s_waitcnt lgkmcnt(8)
    v_mfma_f32_16x16x32_bf16 v[16:19], a[12:15], v[92:95], v[16:19]
    v_mfma_f32_16x16x32_bf16 v[20:23], a[16:19], v[92:95], v[20:23]
    v_mfma_f32_16x16x32_bf16 v[24:27], v[92:95], a[20:23], v[24:27]
    ds_read_b128 v[92:95], v8 offset:16384
    ds_write_b128 v10, v[44:47] offset:1024
    s_waitcnt lgkmcnt(9)
    v_mfma_f32_16x16x32_bf16 v[16:19], a[24:27], v[64:67], v[16:19]
    v_mfma_f32_16x16x32_bf16 v[20:23], a[28:31], v[64:67], v[20:23]
    v_mfma_f32_16x16x32_bf16 v[24:27], v[64:67], a[32:35], v[24:27]
    ds_read_b128 v[64:67], v8 offset:17408
    ds_write_b128 v10, v[48:51] offset:2048
    s_waitcnt lgkmcnt(10)
    v_mfma_f32_16x16x32_bf16 v[16:19], a[36:39], v[68:71], v[16:19]
    v_mfma_f32_16x16x32_bf16 v[20:23], a[40:43], v[68:71], v[20:23]
    v_mfma_f32_16x16x32_bf16 v[24:27], v[68:71], a[44:47], v[24:27]
    ds_read_b128 v[68:71], v8 offset:18432
    ds_write_b128 v10, v[52:55] offset:3072
    s_waitcnt lgkmcnt(11)
    v_mfma_f32_16x16x32_bf16 v[16:19], a[48:51], v[72:75], v[16:19]
    v_mfma_f32_16x16x32_bf16 v[20:23], a[52:55], v[72:75], v[20:23]
    v_mfma_f32_16x16x32_bf16 v[24:27], v[72:75], a[56:59], v[24:27]
    ds_read_b128 v[72:75], v8 offset:19456
    ds_write_b128 v10, v[56:59] offset:4096
    s_waitcnt lgkmcnt(12)
    v_mfma_f32_16x16x32_bf16 v[16:19], a[60:63], v[76:79], v[16:19]
    v_mfma_f32_16x16x32_bf16 v[20:23], a[64:67], v[76:79], v[20:23]
    v_mfma_f32_16x16x32_bf16 v[24:27], v[76:79], a[68:71], v[24:27]
    ds_read_b128 v[76:79], v8 offset:20480
    ds_write_b128 v10, v[60:63] offset:5120
    s_waitcnt lgkmcnt(13)
    v_mfma_f32_16x16x32_bf16 v[16:19], a[72:75], v[80:83], v[16:19]
    v_mfma_f32_16x16x32_bf16 v[20:23], a[76:79], v[80:83], v[20:23]
    v_mfma_f32_16x16x32_bf16 v[24:27], v[80:83], a[80:83], v[24:27]
    s_waitcnt lgkmcnt(0)
    s_barrier
    v_accvgpr_read_b32 v40, a112
    v_accvgpr_read_b32 v41, a113
    v_accvgpr_read_b32 v42, a114
    v_accvgpr_read_b32 v43, a115
    v_accvgpr_read_b32 v44, a116
    v_accvgpr_read_b32 v45, a117
    v_accvgpr_read_b32 v46, a118
    v_accvgpr_read_b32 v47, a119
    v_accvgpr_read_b32 v48, a120
    v_mov_b32 v49, v48
    ds_read_b128 v[96:99], v11 offset:0
    ds_read_b128 v[100:103], v11 offset:1024
    ds_read_b128 v[104:107], v11 offset:2048
    ds_read_b128 v[108:111], v11 offset:3072
    ds_read_b128 v[112:115], v11 offset:4096
    ds_read_b128 v[116:119], v11 offset:5120
    ds_read_b32 v120, v12 offset:0
    ds_read_b32 v122, v12 offset:256
    ds_read_b128 v[50:53], v13 offset:0
    ds_read_b128 v[54:57], v13 offset:256
    v_mfma_f32_16x16x32_bf16 v[28:31], a[0:3], v[84:87], 0
    v_mfma_f32_16x16x32_bf16 v[32:35], a[4:7], v[84:87], 0
    v_mfma_f32_16x16x32_bf16 v[36:39], v[84:87], a[8:11], 0
    v_mfma_f32_16x16x32_bf16 v[28:31], a[12:15], v[88:91], v[28:31]
    v_mfma_f32_16x16x32_bf16 v[32:35], a[16:19], v[88:91], v[32:35]
    v_mfma_f32_16x16x32_bf16 v[36:39], v[88:91], a[20:23], v[36:39]
    v_mfma_f32_16x16x32_bf16 v[28:31], a[24:27], v[92:95], v[28:31]
    v_mfma_f32_16x16x32_bf16 v[32:35], a[28:31], v[92:95], v[32:35]
    v_mfma_f32_16x16x32_bf16 v[36:39], v[92:95], a[32:35], v[36:39]
    s_waitcnt lgkmcnt(0)
    v_mov_b32 v121, v120
    v_mov_b32 v123, v122
    v_add_f32 v16, v16, v96
    v_add_f32 v17, v17, v97
    v_add_f32 v18, v18, v98
    v_add_f32 v19, v19, v99
    v_add_f32 v20, v20, v100
    v_add_f32 v21, v21, v101
    v_add_f32 v22, v22, v102
    v_add_f32 v23, v23, v103
    v_add_f32 v24, v24, v104
    v_add_f32 v25, v25, v105
    v_add_f32 v26, v26, v106
    v_add_f32 v27, v27, v107
    v_mfma_f32_16x16x32_bf16 v[28:31], a[36:39], v[64:67], v[28:31]
    v_mfma_f32_16x16x32_bf16 v[32:35], a[40:43], v[64:67], v[32:35]
    v_mfma_f32_16x16x32_bf16 v[36:39], v[64:67], a[44:47], v[36:39]
    v_pk_mul_f32 v[58:59], v[40:41], v[122:123]
    v_pk_fma_f32 v[16:17], v[16:17], v[120:121], v[58:59]
    v_cvt_pk_bf16_f32 v60, v16, v17
    v_pk_mul_f32 v[58:59], v[42:43], v[122:123]
    v_pk_fma_f32 v[18:19], v[18:19], v[120:121], v[58:59]
    v_cvt_pk_bf16_f32 v61, v18, v19
    v_mfma_f32_16x16x32_bf16 v[28:31], a[48:51], v[68:71], v[28:31]
    v_mfma_f32_16x16x32_bf16 v[32:35], a[52:55], v[68:71], v[32:35]
    v_mfma_f32_16x16x32_bf16 v[36:39], v[68:71], a[56:59], v[36:39]
    v_pk_mul_f32 v[58:59], v[44:45], v[122:123]
    v_pk_fma_f32 v[20:21], v[20:21], v[120:121], v[58:59]
    v_cvt_pk_bf16_f32 v62, v20, v21
    v_pk_mul_f32 v[58:59], v[46:47], v[122:123]
    v_pk_fma_f32 v[22:23], v[22:23], v[120:121], v[58:59]
    v_cvt_pk_bf16_f32 v63, v22, v23
    v_mfma_f32_16x16x32_bf16 v[28:31], a[60:63], v[72:75], v[28:31]
    v_mfma_f32_16x16x32_bf16 v[32:35], a[64:67], v[72:75], v[32:35]
    v_mfma_f32_16x16x32_bf16 v[36:39], v[72:75], a[68:71], v[36:39]
    buffer_store_dwordx4 v[60:63], v5, s[60:63], s64 offen offset:0 sc1
    v_pk_mul_f32 v[58:59], v[48:49], v[54:55]
    v_pk_fma_f32 v[24:25], v[24:25], v[50:51], v[58:59]
    v_cvt_pk_bf16_f32 v124, v24, v25
    v_pk_mul_f32 v[58:59], v[48:49], v[56:57]
    v_pk_fma_f32 v[26:27], v[26:27], v[52:53], v[58:59]
    v_cvt_pk_bf16_f32 v125, v26, v27
    v_mfma_f32_16x16x32_bf16 v[28:31], a[72:75], v[76:79], v[28:31]
    v_mfma_f32_16x16x32_bf16 v[32:35], a[76:79], v[76:79], v[32:35]
    v_mfma_f32_16x16x32_bf16 v[36:39], v[76:79], a[80:83], v[36:39]
    ds_read_b32 v120, v12 offset:64
    ds_read_b32 v122, v12 offset:320
    ds_read_b128 v[50:53], v13 offset:64
    ds_read_b128 v[54:57], v13 offset:320
    s_waitcnt lgkmcnt(0)
    v_mov_b32 v121, v120
    v_mov_b32 v123, v122
    v_add_f32 v28, v28, v108
    v_add_f32 v29, v29, v109
    v_add_f32 v30, v30, v110
    v_add_f32 v31, v31, v111
    v_add_f32 v32, v32, v112
    v_add_f32 v33, v33, v113
    v_add_f32 v34, v34, v114
    v_add_f32 v35, v35, v115
    v_add_f32 v36, v36, v116
    v_add_f32 v37, v37, v117
    v_add_f32 v38, v38, v118
    v_add_f32 v39, v39, v119
    v_pk_mul_f32 v[58:59], v[40:41], v[122:123]
    v_pk_fma_f32 v[28:29], v[28:29], v[120:121], v[58:59]
    v_cvt_pk_bf16_f32 v96, v28, v29
    v_pk_mul_f32 v[58:59], v[42:43], v[122:123]
    v_pk_fma_f32 v[30:31], v[30:31], v[120:121], v[58:59]
    v_cvt_pk_bf16_f32 v97, v30, v31
    v_pk_mul_f32 v[58:59], v[44:45], v[122:123]
    v_pk_fma_f32 v[32:33], v[32:33], v[120:121], v[58:59]
    v_cvt_pk_bf16_f32 v98, v32, v33
    v_pk_mul_f32 v[58:59], v[46:47], v[122:123]
    v_pk_fma_f32 v[34:35], v[34:35], v[120:121], v[58:59]
    v_cvt_pk_bf16_f32 v99, v34, v35
    buffer_store_dwordx4 v[96:99], v5, s[60:63], s64 offen offset:1024 sc1
    v_pk_mul_f32 v[58:59], v[48:49], v[54:55]
    v_pk_fma_f32 v[36:37], v[36:37], v[50:51], v[58:59]
    v_cvt_pk_bf16_f32 v126, v36, v37
    v_pk_mul_f32 v[58:59], v[48:49], v[56:57]
    v_pk_fma_f32 v[38:39], v[38:39], v[52:53], v[58:59]
    v_cvt_pk_bf16_f32 v127, v38, v39
    v_cndmask_b32 v124, v124, v14, vcc
    v_cndmask_b32 v125, v125, v14, vcc
    v_cndmask_b32 v126, v126, v14, vcc
    v_cndmask_b32 v127, v127, v14, vcc
    buffer_store_dwordx4 v[124:127], v5, s[60:63], s65 offen sc1
    s_lshl_b32 s12, s4, 3
    s_add_u32 s12, s12, s5
    s_waitcnt vmcnt(0)
    s_barrier
    s_cmp_lg_u32 s3, 0
    s_cbranch_scc1 m_sig19
    s_lshl_b32 s10, s12, 7
    s_add_u32 s10, s10, 9633792
    v_mov_b32 v10, 0
    v_mov_b32 v8, s56
    v_mov_b32 v9, s57
    s_mov_b64 exec, 1
    buffer_store_dwordx2 v[8:9], v10, s[60:63], s10 offen sc1
    s_mov_b64 exec, -1
m_sig19:
    s_cmp_eq_u32 s7, 1
    s_cselect_b64 s[64:65], -1, 0
    v_mov_b32 v52, 0xf149f2ca
    v_lshlrev_b32 v53, 2, v4
    v_add_u32 v54, 0, v53
    v_cmp_gt_u32 vcc, v54, v3
    s_nop 1
    v_cndmask_b32 v16, v52, 0, vcc
    v_cndmask_b32 v17, 0, v52, vcc
    v_cndmask_b32 v56, v16, v52, s[64:65]
    v_cndmask_b32 v60, 0, v16, s[64:65]
    v_cndmask_b32 v120, v17, 0, s[64:65]
    v_cndmask_b32 v124, v52, v17, s[64:65]
    v_add_u32 v54, 1, v53
    v_cmp_gt_u32 vcc, v54, v3
    s_nop 1
    v_cndmask_b32 v16, v52, 0, vcc
    v_cndmask_b32 v17, 0, v52, vcc
    v_cndmask_b32 v57, v16, v52, s[64:65]
    v_cndmask_b32 v61, 0, v16, s[64:65]
    v_cndmask_b32 v121, v17, 0, s[64:65]
    v_cndmask_b32 v125, v52, v17, s[64:65]
    v_add_u32 v54, 2, v53
    v_cmp_gt_u32 vcc, v54, v3
    s_nop 1
    v_cndmask_b32 v16, v52, 0, vcc
    v_cndmask_b32 v17, 0, v52, vcc
    v_cndmask_b32 v58, v16, v52, s[64:65]
    v_cndmask_b32 v62, 0, v16, s[64:65]
    v_cndmask_b32 v122, v17, 0, s[64:65]
    v_cndmask_b32 v126, v52, v17, s[64:65]
    v_add_u32 v54, 3, v53
    v_cmp_gt_u32 vcc, v54, v3
    s_nop 1
    v_cndmask_b32 v16, v52, 0, vcc
    v_cndmask_b32 v17, 0, v52, vcc
    v_cndmask_b32 v59, v16, v52, s[64:65]
    v_cndmask_b32 v63, 0, v16, s[64:65]
    v_cndmask_b32 v123, v17, 0, s[64:65]
    v_cndmask_b32 v127, v52, v17, s[64:65]
    s_lshl_b32 s12, s9, 17
    s_add_u32 s40, s38, 25165824
    s_addc_u32 s41, s39, 0
    s_add_u32 s40, s40, s12
    s_addc_u32 s41, s41, 0
    s_mov_b32 s42, 131072
    s_mov_b32 s43, 0x00020000
    s_add_u32 s44, s38, 27262976
    s_addc_u32 s45, s39, 0
    s_add_u32 s44, s44, s12
    s_addc_u32 s45, s45, 0
    s_mov_b32 s46, 131072
    s_mov_b32 s47, 0x00020000
    s_add_u32 s48, s38, 29360128
    s_addc_u32 s49, s39, 0
    s_add_u32 s48, s48, s12
    s_addc_u32 s49, s49, 0
    s_mov_b32 s50, 131072
    s_mov_b32 s51, 0x00020000
    s_lshl_b32 s64, s8, 3
    s_mul_i32 s65, s3, 3
    s_add_u32 s66, s64, s65
    s_sub_u32 s58, s66, 16
    s_lshl_b32 s66, s58, 10
    v_add_u32 v18, s66, v5
    v_add_u32 v19, 1024, v18
    v_add_u32 v20, 2048, v18
    s_add_u32 s67, s64, s3
    s_lshl_b32 s68, s67, 10
    s_and_b32 s69, s3, 6
    s_lshl_b32 s12, s69, 10
    v_add_u32 v55, s12, v5
    s_cmp_eq_u32 s3, 0
    s_nop 0
    s_cbranch_scc1 m_nwoa1
    s_mov_b32 s52, s32
    s_mov_b32 s53, s33
    s_mov_b32 s54, 401408
    s_mov_b32 s55, 0x00020000
    v_lshrrev_b32 v48, 3, v2
    v_mul_u32_u24 v49, 896, v48
    v_bfe_u32 v48, v2, 4, 1
    v_lshlrev_b32 v48, 2, v48
    v_and_b32 v50, 7, v2
    v_xor_b32 v48, v48, v50
    v_lshl_add_u32 v49, v48, 4, v49
    s_sub_u32 s12, s3, 1
    s_mul_i32 s10, s12, 57344
    s_lshl_b32 s11, s5, 7
    s_add_u32 s10, s10, s11
    s_lshl_b32 s11, s12, 13
    s_add_u32 s11, s11, 65536
    s_mov_b32 m0, s11
    s_nop 0
    buffer_load_dwordx4 v49, s[52:55], s10 offen lds
    s_add_u32 s10, s10, 7168
    s_add_u32 s11, s11, 1024
    s_mov_b32 m0, s11
    s_nop 0
    buffer_load_dwordx4 v49, s[52:55], s10 offen lds
    s_add_u32 s10, s10, 7168
    s_add_u32 s11, s11, 1024
    s_mov_b32 m0, s11
    s_nop 0
    buffer_load_dwordx4 v49, s[52:55], s10 offen lds
    s_add_u32 s10, s10, 7168
    s_add_u32 s11, s11, 1024
    s_mov_b32 m0, s11
    s_nop 0
    buffer_load_dwordx4 v49, s[52:55], s10 offen lds
    s_add_u32 s10, s10, 7168
    s_add_u32 s11, s11, 1024
    s_mov_b32 m0, s11
    s_nop 0
    buffer_load_dwordx4 v49, s[52:55], s10 offen lds
    s_add_u32 s10, s10, 7168
    s_add_u32 s11, s11, 1024
    s_mov_b32 m0, s11
    s_nop 0
    buffer_load_dwordx4 v49, s[52:55], s10 offen lds
    s_add_u32 s10, s10, 7168
    s_add_u32 s11, s11, 1024
    s_mov_b32 m0, s11
    s_nop 0
    buffer_load_dwordx4 v49, s[52:55], s10 offen lds
    s_add_u32 s10, s10, 7168
    s_add_u32 s11, s11, 1024
    s_mov_b32 m0, s11
    s_nop 0
    buffer_load_dwordx4 v49, s[52:55], s10 offen lds
m_nwoa1:
    s_cmp_lg_u32 s3, 0
    s_cbranch_scc1 m_wd20
    s_lshl_b32 s10, s8, 4
    s_sub_u32 s10, s10, 32
    v_lshrrev_b32 v8, 2, v2
    v_min_u32 v8, 5, v8
    v_lshlrev_b32 v8, 3, v8
    v_add_u32 v8, s10, v8
    v_max_i32 v8, 0, v8
    s_lshr_b32 s11, s9, 2
    s_lshr_b32 s12, s9, 1
    v_and_b32 v9, 1, v2
    v_lshlrev_b32 v9, 2, v9
    v_add_u32 v9, s11, v9
    v_mov_b32 v10, s12
    v_and_b32 v11, 2, v2
    v_cmp_eq_u32 vcc, 0, v11
    s_nop 1
    v_cndmask_b32 v9, v10, v9, vcc
    v_add_u32 v8, v8, v9
    v_lshlrev_b32 v8, 7, v8
    s_mov_b32 s10, 9633792
    s_mov_b32 s11, 0
    buffer_load_dwordx2 v[96:97], v8, s[60:63], s10 offen sc1
    s_sleep 2
m_wl20:
    buffer_load_dwordx2 v[100:101], v8, s[60:63], s10 offen sc1
    s_waitcnt vmcnt(1)
    v_xor_b32 v96, s56, v96
    v_xor_b32 v97, s57, v97
    v_lshrrev_b32 v98, 8, v97
    v_or_b32 v98, v98, v96
    v_cmp_ne_u32 vcc, 0, v98
    s_nop 4
    s_cbranch_vccz m_wa20
    buffer_load_dwordx2 v[96:97], v8, s[60:63], s10 offen sc1
    s_waitcnt vmcnt(1)
    v_xor_b32 v100, s56, v100
    v_xor_b32 v101, s57, v101
    v_lshrrev_b32 v102, 8, v101
    v_or_b32 v102, v102, v100
    v_cmp_ne_u32 vcc, 0, v102
    s_nop 4
    s_cbranch_vccz m_wb20
    s_add_u32 s11, s11, 1
    s_cmp_gt_u32 s11, 200000
    s_cbranch_scc0 m_wl20
    s_branch m_wb20
m_wa20:
m_wb20:
m_wd20:
    s_barrier
    buffer_load_dwordx4 v[12:15], v5, s[40:43], s68 offen sc1
    s_lshl_b32 s12, s65, 10
    s_add_u32 s13, s12, 0
    s_mov_b32 m0, s13
    s_nop 0
    buffer_load_dwordx4 v18, s[44:47], 0 offen sc1 lds
    s_add_u32 s13, s12, 1024
    s_mov_b32 m0, s13
    s_nop 0
    buffer_load_dwordx4 v19, s[44:47], 0 offen sc1 lds
    s_add_u32 s13, s12, 2048
    s_mov_b32 m0, s13
    s_nop 0
    buffer_load_dwordx4 v20, s[44:47], 0 offen sc1 lds
    s_waitcnt vmcnt(0)
    s_add_u32 s13, s12, 24576
    s_mov_b32 m0, s13
    s_nop 0
    buffer_load_dwordx4 v18, s[48:51], 0 offen sc1 lds
    s_add_u32 s13, s12, 25600
    s_mov_b32 m0, s13
    s_nop 0
    buffer_load_dwordx4 v19, s[48:51], 0 offen sc1 lds
    s_add_u32 s13, s12, 26624
    s_mov_b32 m0, s13
    s_nop 0
    buffer_load_dwordx4 v20, s[48:51], 0 offen sc1 lds
    s_barrier
    ds_read_b128 v[16:19], v55 offset:0
    ds_read_b128 v[20:23], v55 offset:1024
    ds_read_b128 v[24:27], v55 offset:2048
    ds_read_b128 v[28:31], v55 offset:3072
    ds_read_b128 v[32:35], v55 offset:4096
    ds_read_b128 v[36:39], v55 offset:5120
    ds_read_b128 v[40:43], v55 offset:6144
    ds_read_b128 v[44:47], v55 offset:7168
    ds_read_b128 v[48:51], v55 offset:8192
    s_waitcnt lgkmcnt(8)
    v_mfma_f32_16x16x32_bf16 v[56:59], v[16:19], v[12:15], v[56:59]
    s_waitcnt lgkmcnt(7)
    v_mfma_f32_16x16x32_bf16 v[60:63], v[20:23], v[12:15], v[60:63]
    s_waitcnt lgkmcnt(6)
    v_mfma_f32_16x16x32_bf16 v[64:67], v[24:27], v[12:15], 0
    s_waitcnt lgkmcnt(5)
    v_mfma_f32_16x16x32_bf16 v[68:71], v[28:31], v[12:15], 0
    s_waitcnt lgkmcnt(4)
    v_mfma_f32_16x16x32_bf16 v[72:75], v[32:35], v[12:15], 0
    s_waitcnt lgkmcnt(3)
    v_mfma_f32_16x16x32_bf16 v[76:79], v[36:39], v[12:15], 0
    s_waitcnt lgkmcnt(2)
    v_mfma_f32_16x16x32_bf16 v[80:83], v[40:43], v[12:15], 0
    s_waitcnt lgkmcnt(1)
    v_mfma_f32_16x16x32_bf16 v[84:87], v[44:47], v[12:15], 0
    s_waitcnt lgkmcnt(0)
    v_mfma_f32_16x16x32_bf16 v[88:91], v[48:51], v[12:15], 0
    ds_read_b128 v[16:19], v55 offset:9216
    ds_read_b128 v[20:23], v55 offset:10240
    ds_read_b128 v[24:27], v55 offset:11264
    ds_read_b128 v[28:31], v55 offset:12288
    ds_read_b128 v[32:35], v55 offset:13312
    ds_read_b128 v[36:39], v55 offset:14336
    ds_read_b128 v[40:43], v55 offset:15360
    ds_read_b128 v[44:47], v55 offset:16384
    ds_read_b128 v[48:51], v55 offset:17408
    s_waitcnt lgkmcnt(8)
    v_mfma_f32_16x16x32_bf16 v[92:95], v[16:19], v[12:15], 0
    s_waitcnt lgkmcnt(7)
    v_mfma_f32_16x16x32_bf16 v[96:99], v[20:23], v[12:15], 0
    s_waitcnt lgkmcnt(6)
    v_mfma_f32_16x16x32_bf16 v[100:103], v[24:27], v[12:15], 0
    s_waitcnt lgkmcnt(5)
    v_mfma_f32_16x16x32_bf16 v[104:107], v[28:31], v[12:15], 0
    s_waitcnt lgkmcnt(4)
    v_mfma_f32_16x16x32_bf16 v[108:111], v[32:35], v[12:15], 0
    s_waitcnt lgkmcnt(3)
    v_mfma_f32_16x16x32_bf16 v[112:115], v[36:39], v[12:15], 0
    s_waitcnt lgkmcnt(2)
    v_mfma_f32_16x16x32_bf16 v[116:119], v[40:43], v[12:15], 0
    s_waitcnt lgkmcnt(1)
    v_mfma_f32_16x16x32_bf16 v[120:123], v[44:47], v[12:15], v[120:123]
    s_waitcnt lgkmcnt(0)
    v_mfma_f32_16x16x32_bf16 v[124:127], v[48:51], v[12:15], v[124:127]
    s_cmp_ge_u32 s8, 2
    s_nop 6
    s_cbranch_scc1 m_nea1
    s_sub_u32 s12, 16, s64
    s_sub_u32 s12, s12, s69
    s_cmp_gt_i32 s12, 0
    s_cselect_b32 s13, 0xf149f2ca, 0
    v_add_f32 v56, s13, v56
    v_add_f32 v57, s13, v57
    v_add_f32 v58, s13, v58
    v_add_f32 v59, s13, v59
    s_cmp_gt_i32 s12, 1
    s_cselect_b32 s13, 0xf149f2ca, 0
    v_add_f32 v60, s13, v60
    v_add_f32 v61, s13, v61
    v_add_f32 v62, s13, v62
    v_add_f32 v63, s13, v63
    s_cmp_gt_i32 s12, 2
    s_cselect_b32 s13, 0xf149f2ca, 0
    v_add_f32 v64, s13, v64
    v_add_f32 v65, s13, v65
    v_add_f32 v66, s13, v66
    v_add_f32 v67, s13, v67
    s_cmp_gt_i32 s12, 3
    s_cselect_b32 s13, 0xf149f2ca, 0
    v_add_f32 v68, s13, v68
    v_add_f32 v69, s13, v69
    v_add_f32 v70, s13, v70
    v_add_f32 v71, s13, v71
    s_cmp_gt_i32 s12, 4
    s_cselect_b32 s13, 0xf149f2ca, 0
    v_add_f32 v72, s13, v72
    v_add_f32 v73, s13, v73
    v_add_f32 v74, s13, v74
    v_add_f32 v75, s13, v75
    s_cmp_gt_i32 s12, 5
    s_cselect_b32 s13, 0xf149f2ca, 0
    v_add_f32 v76, s13, v76
    v_add_f32 v77, s13, v77
    v_add_f32 v78, s13, v78
    v_add_f32 v79, s13, v79
    s_cmp_gt_i32 s12, 6
    s_cselect_b32 s13, 0xf149f2ca, 0
    v_add_f32 v80, s13, v80
    v_add_f32 v81, s13, v81
    v_add_f32 v82, s13, v82
    v_add_f32 v83, s13, v83
    s_cmp_gt_i32 s12, 7
    s_cselect_b32 s13, 0xf149f2ca, 0
    v_add_f32 v84, s13, v84
    v_add_f32 v85, s13, v85
    v_add_f32 v86, s13, v86
    v_add_f32 v87, s13, v87
    s_cmp_gt_i32 s12, 8
    s_cselect_b32 s13, 0xf149f2ca, 0
    v_add_f32 v88, s13, v88
    v_add_f32 v89, s13, v89
    v_add_f32 v90, s13, v90
    v_add_f32 v91, s13, v91
    s_cmp_gt_i32 s12, 9
    s_cselect_b32 s13, 0xf149f2ca, 0
    v_add_f32 v92, s13, v92
    v_add_f32 v93, s13, v93
    v_add_f32 v94, s13, v94
    v_add_f32 v95, s13, v95
    s_cmp_gt_i32 s12, 10
    s_cselect_b32 s13, 0xf149f2ca, 0
    v_add_f32 v96, s13, v96
    v_add_f32 v97, s13, v97
    v_add_f32 v98, s13, v98
    v_add_f32 v99, s13, v99
    s_cmp_gt_i32 s12, 11
    s_cselect_b32 s13, 0xf149f2ca, 0
    v_add_f32 v100, s13, v100
    v_add_f32 v101, s13, v101
    v_add_f32 v102, s13, v102
    v_add_f32 v103, s13, v103
    s_cmp_gt_i32 s12, 12
    s_cselect_b32 s13, 0xf149f2ca, 0
    v_add_f32 v104, s13, v104
    v_add_f32 v105, s13, v105
    v_add_f32 v106, s13, v106
    v_add_f32 v107, s13, v107
    s_cmp_gt_i32 s12, 13
    s_cselect_b32 s13, 0xf149f2ca, 0
    v_add_f32 v108, s13, v108
    v_add_f32 v109, s13, v109
    v_add_f32 v110, s13, v110
    v_add_f32 v111, s13, v111
    s_cmp_gt_i32 s12, 14
    s_cselect_b32 s13, 0xf149f2ca, 0
    v_add_f32 v112, s13, v112
    v_add_f32 v113, s13, v113
    v_add_f32 v114, s13, v114
    v_add_f32 v115, s13, v115
    s_cmp_gt_i32 s12, 15
    s_cselect_b32 s13, 0xf149f2ca, 0
    v_add_f32 v116, s13, v116
    v_add_f32 v117, s13, v117
    v_add_f32 v118, s13, v118
    v_add_f32 v119, s13, v119
    s_nop 1
m_nea1:
    v_max3_f32 v52, v56, v57, v58
    v_max3_f32 v53, v59, v60, v61
    v_max3_f32 v52, v52, v62, v63
    v_max3_f32 v53, v53, v64, v65
    v_max3_f32 v52, v52, v66, v67
    v_max3_f32 v53, v53, v68, v69
    v_max3_f32 v52, v52, v70, v71
    v_max3_f32 v53, v53, v72, v73
    v_max3_f32 v52, v52, v74, v75
    v_max3_f32 v53, v53, v76, v77
    v_max3_f32 v52, v52, v78, v79
    v_max3_f32 v53, v53, v80, v81
    v_max3_f32 v52, v52, v82, v83
    v_max3_f32 v53, v53, v84, v85
    v_max3_f32 v52, v52, v86, v87
    v_max3_f32 v53, v53, v88, v89
    v_max3_f32 v52, v52, v90, v91
    v_max3_f32 v53, v53, v92, v93
    v_max3_f32 v52, v52, v94, v95
    v_max3_f32 v53, v53, v96, v97
    v_max3_f32 v52, v52, v98, v99
    v_max3_f32 v53, v53, v100, v101
    v_max3_f32 v52, v52, v102, v103
    v_max3_f32 v53, v53, v104, v105
    v_max3_f32 v52, v52, v106, v107
    v_max3_f32 v53, v53, v108, v109
    v_max3_f32 v52, v52, v110, v111
    v_max3_f32 v53, v53, v112, v113
    v_max3_f32 v52, v52, v114, v115
    v_max3_f32 v53, v53, v116, v117
    v_max3_f32 v52, v52, v118, v119
    v_max3_f32 v53, v53, v120, v121
    v_max3_f32 v52, v52, v122, v123
    v_max3_f32 v53, v53, v124, v125
    v_max3_f32 v52, v52, v126, v127
    v_max_f32 v52, v52, v53
    v_mov_b32 v53, v52
    s_nop 1
    v_permlane16_swap_b32 v52, v53
    v_max_f32 v52, v52, v53
    v_mov_b32 v53, v52
    s_nop 1
    v_permlane32_swap_b32 v52, v53
    v_max_f32 v52, v52, v53
    v_mul_f32 v52, -v52, s79
    v_mov_b32 v53, v52
    v_mov_b32 v48, s79
    v_mov_b32 v49, s79
    v_fmamk_f32 v56, v56, 0x3e8b97f6, v52
    v_fmamk_f32 v57, v57, 0x3e8b97f6, v52
    v_fmamk_f32 v58, v58, 0x3e8b97f6, v52
    v_fmamk_f32 v59, v59, 0x3e8b97f6, v52
    v_fmamk_f32 v60, v60, 0x3e8b97f6, v52
    v_fmamk_f32 v61, v61, 0x3e8b97f6, v52
    v_fmamk_f32 v62, v62, 0x3e8b97f6, v52
    v_fmamk_f32 v63, v63, 0x3e8b97f6, v52
    v_exp_f32 v56, v56
    v_exp_f32 v57, v57
    v_exp_f32 v58, v58
    v_exp_f32 v59, v59
    v_exp_f32 v60, v60
    v_exp_f32 v61, v61
    v_exp_f32 v62, v62
    v_exp_f32 v63, v63
    v_cvt_pk_bf16_f32 v56, v56, v57
    v_cvt_pk_bf16_f32 v57, v58, v59
    v_cvt_pk_bf16_f32 v58, v60, v61
    v_cvt_pk_bf16_f32 v59, v62, v63
    v_fmamk_f32 v64, v64, 0x3e8b97f6, v52
    v_fmamk_f32 v65, v65, 0x3e8b97f6, v52
    v_fmamk_f32 v66, v66, 0x3e8b97f6, v52
    v_fmamk_f32 v67, v67, 0x3e8b97f6, v52
    v_fmamk_f32 v68, v68, 0x3e8b97f6, v52
    v_fmamk_f32 v69, v69, 0x3e8b97f6, v52
    v_fmamk_f32 v70, v70, 0x3e8b97f6, v52
    v_fmamk_f32 v71, v71, 0x3e8b97f6, v52
    v_exp_f32 v64, v64
    v_exp_f32 v65, v65
    v_exp_f32 v66, v66
    v_exp_f32 v67, v67
    v_exp_f32 v68, v68
    v_exp_f32 v69, v69
    v_exp_f32 v70, v70
    v_exp_f32 v71, v71
    v_cvt_pk_bf16_f32 v64, v64, v65
    v_cvt_pk_bf16_f32 v65, v66, v67
    v_cvt_pk_bf16_f32 v66, v68, v69
    v_cvt_pk_bf16_f32 v67, v70, v71
    v_fmamk_f32 v72, v72, 0x3e8b97f6, v52
    v_fmamk_f32 v73, v73, 0x3e8b97f6, v52
    v_fmamk_f32 v74, v74, 0x3e8b97f6, v52
    v_fmamk_f32 v75, v75, 0x3e8b97f6, v52
    v_fmamk_f32 v76, v76, 0x3e8b97f6, v52
    v_fmamk_f32 v77, v77, 0x3e8b97f6, v52
    v_fmamk_f32 v78, v78, 0x3e8b97f6, v52
    v_fmamk_f32 v79, v79, 0x3e8b97f6, v52
    v_exp_f32 v72, v72
    v_exp_f32 v73, v73
    v_exp_f32 v74, v74
    v_exp_f32 v75, v75
    v_exp_f32 v76, v76
    v_exp_f32 v77, v77
    v_exp_f32 v78, v78
    v_exp_f32 v79, v79
    v_cvt_pk_bf16_f32 v72, v72, v73
    v_cvt_pk_bf16_f32 v73, v74, v75
    v_cvt_pk_bf16_f32 v74, v76, v77
    v_cvt_pk_bf16_f32 v75, v78, v79
    s_waitcnt vmcnt(0)
    s_barrier
    ds_read_b128 v[16:19], v55 offset:24576
    ds_read_b128 v[20:23], v55 offset:25600
    ds_read_b128 v[24:27], v55 offset:26624
    ds_read_b128 v[28:31], v55 offset:27648
    ds_read_b128 v[32:35], v55 offset:28672
    ds_read_b128 v[36:39], v55 offset:29696
    ds_read_b128 v[40:43], v55 offset:30720
    ds_read_b128 v[44:47], v55 offset:31744
    v_fmamk_f32 v80, v80, 0x3e8b97f6, v52
    v_fmamk_f32 v81, v81, 0x3e8b97f6, v52
    v_fmamk_f32 v82, v82, 0x3e8b97f6, v52
    v_fmamk_f32 v83, v83, 0x3e8b97f6, v52
    v_fmamk_f32 v84, v84, 0x3e8b97f6, v52
    v_fmamk_f32 v85, v85, 0x3e8b97f6, v52
    v_fmamk_f32 v86, v86, 0x3e8b97f6, v52
    v_fmamk_f32 v87, v87, 0x3e8b97f6, v52
    v_exp_f32 v80, v80
    v_exp_f32 v81, v81
    v_exp_f32 v82, v82
    v_exp_f32 v83, v83
    v_exp_f32 v84, v84
    v_exp_f32 v85, v85
    v_exp_f32 v86, v86
    v_exp_f32 v87, v87
    v_cvt_pk_bf16_f32 v80, v80, v81
    v_cvt_pk_bf16_f32 v81, v82, v83
    v_cvt_pk_bf16_f32 v82, v84, v85
    v_cvt_pk_bf16_f32 v83, v86, v87
    s_waitcnt lgkmcnt(6)
    v_mfma_f32_16x16x32_bf16 v[8:11], v[16:19], v[56:59], 0
    v_mfma_f32_16x16x32_bf16 v[12:15], v[20:23], v[56:59], 0
    ds_read_b128 v[16:19], v55 offset:32768
    ds_read_b128 v[20:23], v55 offset:33792
    s_waitcnt lgkmcnt(6)
    v_mfma_f32_16x16x32_bf16 v[8:11], v[24:27], v[64:67], v[8:11]
    v_mfma_f32_16x16x32_bf16 v[12:15], v[28:31], v[64:67], v[12:15]
    ds_read_b128 v[24:27], v55 offset:34816
    ds_read_b128 v[28:31], v55 offset:35840
    v_fmamk_f32 v88, v88, 0x3e8b97f6, v52
    v_fmamk_f32 v89, v89, 0x3e8b97f6, v52
    v_fmamk_f32 v90, v90, 0x3e8b97f6, v52
    v_fmamk_f32 v91, v91, 0x3e8b97f6, v52
    v_fmamk_f32 v92, v92, 0x3e8b97f6, v52
    v_fmamk_f32 v93, v93, 0x3e8b97f6, v52
    v_fmamk_f32 v94, v94, 0x3e8b97f6, v52
    v_fmamk_f32 v95, v95, 0x3e8b97f6, v52
    v_exp_f32 v88, v88
    v_exp_f32 v89, v89
    v_exp_f32 v90, v90
    v_exp_f32 v91, v91
    v_exp_f32 v92, v92
    v_exp_f32 v93, v93
    v_exp_f32 v94, v94
    v_exp_f32 v95, v95
    v_cvt_pk_bf16_f32 v88, v88, v89
    v_cvt_pk_bf16_f32 v89, v90, v91
    v_cvt_pk_bf16_f32 v90, v92, v93
    v_cvt_pk_bf16_f32 v91, v94, v95
    s_waitcnt lgkmcnt(6)
    v_mfma_f32_16x16x32_bf16 v[8:11], v[32:35], v[72:75], v[8:11]
    v_mfma_f32_16x16x32_bf16 v[12:15], v[36:39], v[72:75], v[12:15]
    ds_read_b128 v[32:35], v55 offset:36864
    ds_read_b128 v[36:39], v55 offset:37888
    s_waitcnt lgkmcnt(6)
    v_mfma_f32_16x16x32_bf16 v[8:11], v[40:43], v[80:83], v[8:11]
    v_mfma_f32_16x16x32_bf16 v[12:15], v[44:47], v[80:83], v[12:15]
    ds_read_b128 v[40:43], v55 offset:38912
    ds_read_b128 v[44:47], v55 offset:39936
    v_fmamk_f32 v96, v96, 0x3e8b97f6, v52
    v_fmamk_f32 v97, v97, 0x3e8b97f6, v52
    v_fmamk_f32 v98, v98, 0x3e8b97f6, v52
    v_fmamk_f32 v99, v99, 0x3e8b97f6, v52
    v_fmamk_f32 v100, v100, 0x3e8b97f6, v52
    v_fmamk_f32 v101, v101, 0x3e8b97f6, v52
    v_fmamk_f32 v102, v102, 0x3e8b97f6, v52
    v_fmamk_f32 v103, v103, 0x3e8b97f6, v52
    v_exp_f32 v96, v96
    v_exp_f32 v97, v97
    v_exp_f32 v98, v98
    v_exp_f32 v99, v99
    v_exp_f32 v100, v100
    v_exp_f32 v101, v101
    v_exp_f32 v102, v102
    v_exp_f32 v103, v103
    v_cvt_pk_bf16_f32 v96, v96, v97
    v_cvt_pk_bf16_f32 v97, v98, v99
    v_cvt_pk_bf16_f32 v98, v100, v101
    v_cvt_pk_bf16_f32 v99, v102, v103
    s_waitcnt lgkmcnt(6)
    v_mfma_f32_16x16x32_bf16 v[8:11], v[16:19], v[88:91], v[8:11]
    v_mfma_f32_16x16x32_bf16 v[12:15], v[20:23], v[88:91], v[12:15]
    ds_read_b128 v[16:19], v55 offset:40960
    ds_read_b128 v[20:23], v55 offset:41984
    s_waitcnt lgkmcnt(6)
    v_mfma_f32_16x16x32_bf16 v[8:11], v[24:27], v[96:99], v[8:11]
    v_mfma_f32_16x16x32_bf16 v[12:15], v[28:31], v[96:99], v[12:15]
    v_fmamk_f32 v104, v104, 0x3e8b97f6, v52
    v_fmamk_f32 v105, v105, 0x3e8b97f6, v52
    v_fmamk_f32 v106, v106, 0x3e8b97f6, v52
    v_fmamk_f32 v107, v107, 0x3e8b97f6, v52
    v_fmamk_f32 v108, v108, 0x3e8b97f6, v52
    v_fmamk_f32 v109, v109, 0x3e8b97f6, v52
    v_fmamk_f32 v110, v110, 0x3e8b97f6, v52
    v_fmamk_f32 v111, v111, 0x3e8b97f6, v52
    v_exp_f32 v104, v104
    v_exp_f32 v105, v105
    v_exp_f32 v106, v106
    v_exp_f32 v107, v107
    v_exp_f32 v108, v108
    v_exp_f32 v109, v109
    v_exp_f32 v110, v110
    v_exp_f32 v111, v111
    v_cvt_pk_bf16_f32 v104, v104, v105
    v_cvt_pk_bf16_f32 v105, v106, v107
    v_cvt_pk_bf16_f32 v106, v108, v109
    v_cvt_pk_bf16_f32 v107, v110, v111
    s_waitcnt lgkmcnt(4)
    s_nop 0
    v_mfma_f32_16x16x32_bf16 v[8:11], v[32:35], v[104:107], v[8:11]
    v_mfma_f32_16x16x32_bf16 v[12:15], v[36:39], v[104:107], v[12:15]
    v_fmamk_f32 v112, v112, 0x3e8b97f6, v52
    v_fmamk_f32 v113, v113, 0x3e8b97f6, v52
    v_fmamk_f32 v114, v114, 0x3e8b97f6, v52
    v_fmamk_f32 v115, v115, 0x3e8b97f6, v52
    v_fmamk_f32 v116, v116, 0x3e8b97f6, v52
    v_fmamk_f32 v117, v117, 0x3e8b97f6, v52
    v_fmamk_f32 v118, v118, 0x3e8b97f6, v52
    v_fmamk_f32 v119, v119, 0x3e8b97f6, v52
    v_exp_f32 v112, v112
    v_exp_f32 v113, v113
    v_exp_f32 v114, v114
    v_exp_f32 v115, v115
    v_exp_f32 v116, v116
    v_exp_f32 v117, v117
    v_exp_f32 v118, v118
    v_exp_f32 v119, v119
    v_cvt_pk_bf16_f32 v112, v112, v113
    v_cvt_pk_bf16_f32 v113, v114, v115
    v_cvt_pk_bf16_f32 v114, v116, v117
    v_cvt_pk_bf16_f32 v115, v118, v119
    v_fmamk_f32 v120, v120, 0x3e8b97f6, v52
    v_fmamk_f32 v121, v121, 0x3e8b97f6, v52
    v_fmamk_f32 v122, v122, 0x3e8b97f6, v52
    v_fmamk_f32 v123, v123, 0x3e8b97f6, v52
    v_fmamk_f32 v124, v124, 0x3e8b97f6, v52
    v_fmamk_f32 v125, v125, 0x3e8b97f6, v52
    v_fmamk_f32 v126, v126, 0x3e8b97f6, v52
    v_fmamk_f32 v127, v127, 0x3e8b97f6, v52
    v_exp_f32 v120, v120
    v_exp_f32 v121, v121
    v_exp_f32 v122, v122
    v_exp_f32 v123, v123
    v_exp_f32 v124, v124
    v_exp_f32 v125, v125
    v_exp_f32 v126, v126
    v_exp_f32 v127, v127
    v_cvt_pk_bf16_f32 v120, v120, v121
    v_cvt_pk_bf16_f32 v121, v122, v123
    v_cvt_pk_bf16_f32 v122, v124, v125
    v_cvt_pk_bf16_f32 v123, v126, v127
    s_waitcnt lgkmcnt(2)
    v_mfma_f32_16x16x32_bf16 v[8:11], v[40:43], v[112:115], v[8:11]
    v_mfma_f32_16x16x32_bf16 v[12:15], v[44:47], v[112:115], v[12:15]
    s_waitcnt lgkmcnt(0)
    v_mfma_f32_16x16x32_bf16 v[8:11], v[16:19], v[120:123], v[8:11]
    v_mfma_f32_16x16x32_bf16 v[12:15], v[20:23], v[120:123], v[12:15]
    v_cmp_eq_u32 vcc, 3, v4
    s_nop 6
    v_cndmask_b32 v52, 0, v12, vcc
    v_mov_b32 v53, v52
    s_nop 1
    v_permlane16_swap_b32 v52, v53
    v_add_f32 v52, v52, v53
    v_mov_b32 v53, v52
    s_nop 1
    v_permlane32_swap_b32 v52, v53
    v_add_f32 v52, v52, v53
    v_rcp_f32 v52, v52
    s_nop 0
    v_mul_f32 v8, v8, v52
    v_mul_f32 v9, v9, v52
    v_mul_f32 v10, v10, v52
    v_mul_f32 v11, v11, v52
    v_mul_f32 v12, v12, v52
    v_mul_f32 v13, v13, v52
    v_mul_f32 v14, v14, v52
    v_mul_f32 v15, v15, v52
    v_cvt_pk_bf16_f32 v16, v8, v9
    v_cvt_pk_bf16_f32 v17, v10, v11
    v_cvt_pk_bf16_f32 v18, v12, v13
    v_cvt_pk_bf16_f32 v19, v14, v15
    s_lshl_b32 s12, s67, 4
    s_add_u32 s12, s12, s9
    s_lshl_b32 s12, s12, 10
    s_add_u32 s12, s12, 31457280
    buffer_store_dwordx4 v[16:19], v5, s[60:63], s12 offen  sc1
    s_lshl_b32 s12, s8, 4
    s_add_u32 s12, s12, s9
    s_waitcnt vmcnt(0)
    s_barrier
    s_cmp_lg_u32 s3, 0
    s_cbranch_scc1 m_sig21
    s_lshl_b32 s10, s12, 7
    s_add_u32 s10, s10, 9666560
    v_mov_b32 v10, 0
    v_mov_b32 v8, s56
    v_mov_b32 v9, s57
    s_mov_b64 exec, 1
    s_cmp_lg_u32 s75, 0
    s_cselect_b32 s14, s10, 0x40000000
    s_cselect_b32 s15, 0x40000000, s10
    buffer_store_dwordx2 v[8:9], v10, s[60:63], s14 offen
    buffer_store_dwordx2 v[8:9], v10, s[60:63], s15 offen  sc1
    s_mov_b64 exec, -1
m_sig21:
    s_cmp_eq_u32 s5, 7
    s_cbranch_scc1 m_skipo1
    s_bfe_u32 s64, s3, 0x10001
    s_lshr_b32 s65, s3, 2
    s_lshl_b32 s66, s65, 1
    s_add_u32 s66, s66, s7
    s_xor_b32 s67, s66, 1
    s_lshl_b32 s10, s7, 13
    s_lshl_b32 s11, s66, 14
    s_add_u32 s11, s11, s10
    v_add_u32 v16, s11, v5
    s_lshl_b32 s11, s67, 14
    s_add_u32 s11, s11, s10
    v_add_u32 v17, s11, v5
    v_bfe_u32 v18, v2, 2, 2
    v_lshrrev_b32 v23, 1, v18
    v_xor_b32 v23, s64, v23
    v_lshl_add_u32 v18, v4, 3, v18
    v_lshlrev_b32 v18, 7, v18
    v_lshl_add_u32 v18, v23, 6, v18
    v_and_b32 v23, 3, v2
    v_lshl_add_u32 v18, v23, 4, v18
    s_mul_i32 s11, s7, 28672
    s_add_u32 s11, s11, 65536
    v_add_u32 v18, s11, v18
    v_subrev_u32 v23, 3, v4
    v_ashrrev_i32 v23, 31, v23
    s_lshl_b32 s10, s4, 6
    s_lshl_b32 s11, s66, 4
    s_add_u32 s10, s10, s11
    v_add_u32 v19, s10, v3
    s_movk_i32 s11, 896
    v_mul_lo_u32 v19, v19, s11
    s_lshl_b32 s10, s5, 7
    s_lshl_b32 s11, s64, 6
    s_add_u32 s10, s10, s11
    v_lshl_add_u32 v19, v4, 4, v19
    v_add_u32 v19, s10, v19
    s_lshl_b32 s10, s66, 1
    s_add_u32 s10, s10, s64
    s_lshl_b32 s10, s10, 10
    s_add_u32 s10, s10, 131072
    v_add_u32 v20, s10, v5
    ds_read_b128 v[24:27], v20
    s_lshl_b32 s10, s3, 11
    s_add_u32 s10, s10, 139264
    v_add_u32 v21, s10, v5
    v_xor_b32 v22, 2048, v21
    s_mov_b32 s40, s34
    s_mov_b32 s41, s35
    s_mov_b32 s42, 1835008
    s_mov_b32 s43, 0x00020000
    s_cmp_lg_u32 s3, 0
    s_cbranch_scc1 m_wd22
    s_lshr_b32 s10, s4, 1
    s_lshl_b32 s10, s10, 4
    v_add_u32 v8, 0, v2
    v_min_u32 v8, 15, v8
    v_add_u32 v8, s10, v8
    v_max_i32 v8, 0, v8
    v_lshlrev_b32 v8, 7, v8
    s_mov_b32 s10, 9666560
    s_mov_b32 s11, 0
    buffer_load_dwordx2 v[108:109], v8, s[60:63], s10 offen sc1
    s_sleep 2
m_wl22:
    buffer_load_dwordx2 v[112:113], v8, s[60:63], s10 offen sc1
    s_waitcnt vmcnt(1)
    v_xor_b32 v108, s56, v108
    v_xor_b32 v109, s57, v109
    v_lshrrev_b32 v110, 8, v109
    v_or_b32 v110, v110, v108
    v_cmp_ne_u32 vcc, 0, v110
    s_nop 4
    s_cbranch_vccz m_wa22
    buffer_load_dwordx2 v[108:109], v8, s[60:63], s10 offen sc1
    s_waitcnt vmcnt(1)
    v_xor_b32 v112, s56, v112
    v_xor_b32 v113, s57, v113
    v_lshrrev_b32 v114, 8, v113
    v_or_b32 v114, v114, v112
    v_cmp_ne_u32 vcc, 0, v114
    s_nop 4
    s_cbranch_vccz m_wb22
    s_add_u32 s11, s11, 1
    s_cmp_gt_u32 s11, 200000
    s_cbranch_scc0 m_wl22
    s_branch m_wb22
m_wa22:
m_wb22:
m_wd22:
    s_barrier
    s_lshl_b32 s10, s4, 16
    s_lshl_b32 s11, s3, 13
    s_add_u32 s10, s10, s11
    s_add_u32 s10, s10, 31457280
    s_mov_b32 m0, s11
    s_nop 0
    buffer_load_dwordx4 v5, s[60:63], s10 offen offset:0 sc1 lds
    buffer_load_dwordx4 v5, s[60:63], s10 offen offset:1024 sc1 lds
    buffer_load_dwordx4 v5, s[60:63], s10 offen offset:2048 sc1 lds
    buffer_load_dwordx4 v5, s[60:63], s10 offen offset:3072 sc1 lds
    s_add_u32 s10, s10, 4096
    s_add_u32 s11, s11, 4096
    s_mov_b32 m0, s11
    s_nop 0
    buffer_load_dwordx4 v5, s[60:63], s10 offen offset:0 sc1 lds
    buffer_load_dwordx4 v5, s[60:63], s10 offen offset:1024 sc1 lds
    buffer_load_dwordx4 v5, s[60:63], s10 offen offset:2048 sc1 lds
    buffer_load_dwordx4 v5, s[60:63], s10 offen offset:3072 sc1 lds
    ds_read_b64_tr_b16 v[44:45], v18 offset:0
    ds_read_b64_tr_b16 v[46:47], v18 offset:512
    ds_read_b64_tr_b16 v[48:49], v18 offset:8
    ds_read_b64_tr_b16 v[50:51], v18 offset:520
    ds_read_b64_tr_b16 v[52:53], v18 offset:3584
    ds_read_b64_tr_b16 v[54:55], v18 offset:4096
    ds_read_b64_tr_b16 v[56:57], v18 offset:3592
    ds_read_b64_tr_b16 v[58:59], v18 offset:4104
    ds_read_b64_tr_b16 v[60:61], v18 offset:7168
    ds_read_b64_tr_b16 v[62:63], v18 offset:7680
    ds_read_b64_tr_b16 v[64:65], v18 offset:7176
    ds_read_b64_tr_b16 v[66:67], v18 offset:7688
    ds_read_b64_tr_b16 v[68:69], v18 offset:10752
    ds_read_b64_tr_b16 v[70:71], v18 offset:11264
    ds_read_b64_tr_b16 v[72:73], v18 offset:10760
    ds_read_b64_tr_b16 v[74:75], v18 offset:11272
    ds_read_b64_tr_b16 v[76:77], v18 offset:14336
    ds_read_b64_tr_b16 v[78:79], v18 offset:14848
    ds_read_b64_tr_b16 v[80:81], v18 offset:14344
    ds_read_b64_tr_b16 v[82:83], v18 offset:14856
    ds_read_b64_tr_b16 v[84:85], v18 offset:17920
    ds_read_b64_tr_b16 v[86:87], v18 offset:18432
    ds_read_b64_tr_b16 v[88:89], v18 offset:17928
    ds_read_b64_tr_b16 v[90:91], v18 offset:18440
    ds_read_b64_tr_b16 v[92:93], v18 offset:21504
    ds_read_b64_tr_b16 v[94:95], v18 offset:22016
    ds_read_b64_tr_b16 v[96:97], v18 offset:21512
    ds_read_b64_tr_b16 v[98:99], v18 offset:22024
    ds_read_b64_tr_b16 v[100:101], v18 offset:25088
    ds_read_b64_tr_b16 v[102:103], v18 offset:25600
    ds_read_b64_tr_b16 v[104:105], v18 offset:25096
    ds_read_b64_tr_b16 v[106:107], v18 offset:25608
    s_waitcnt lgkmcnt(0)
    v_and_b32 v46, v23, v46
    v_and_b32 v47, v23, v47
    v_and_b32 v50, v23, v50
    v_and_b32 v51, v23, v51
    v_and_b32 v54, v23, v54
    v_and_b32 v55, v23, v55
    v_and_b32 v58, v23, v58
    v_and_b32 v59, v23, v59
    v_and_b32 v62, v23, v62
    v_and_b32 v63, v23, v63
    v_and_b32 v66, v23, v66
    v_and_b32 v67, v23, v67
    v_and_b32 v70, v23, v70
    v_and_b32 v71, v23, v71
    v_and_b32 v74, v23, v74
    v_and_b32 v75, v23, v75
    v_and_b32 v78, v23, v78
    v_and_b32 v79, v23, v79
    v_and_b32 v82, v23, v82
    v_and_b32 v83, v23, v83
    v_and_b32 v86, v23, v86
    v_and_b32 v87, v23, v87
    v_and_b32 v90, v23, v90
    v_and_b32 v91, v23, v91
    v_and_b32 v94, v23, v94
    v_and_b32 v95, v23, v95
    v_and_b32 v98, v23, v98
    v_and_b32 v99, v23, v99
    v_and_b32 v102, v23, v102
    v_and_b32 v103, v23, v103
    v_and_b32 v106, v23, v106
    v_and_b32 v107, v23, v107
    s_waitcnt vmcnt(4)
    s_barrier
    ds_read_b128 v[108:111], v16 offset:0
    ds_read_b128 v[112:115], v17 offset:0
    ds_read_b128 v[116:119], v16 offset:1024
    ds_read_b128 v[120:123], v17 offset:1024
    ds_read_b128 v[124:127], v16 offset:2048
    ds_read_b128 v[128:131], v17 offset:2048
    s_waitcnt lgkmcnt(4)
    v_mfma_f32_16x16x32_bf16 v[28:31], v[44:47], v[108:111], 0
    v_mfma_f32_16x16x32_bf16 v[32:35], v[48:51], v[108:111], 0
    v_mfma_f32_16x16x32_bf16 v[36:39], v[44:47], v[112:115], 0
    v_mfma_f32_16x16x32_bf16 v[40:43], v[48:51], v[112:115], 0
    ds_read_b128 v[108:111], v16 offset:3072
    ds_read_b128 v[112:115], v17 offset:3072
    s_waitcnt lgkmcnt(4)
    v_mfma_f32_16x16x32_bf16 v[28:31], v[52:55], v[116:119], v[28:31]
    v_mfma_f32_16x16x32_bf16 v[32:35], v[56:59], v[116:119], v[32:35]
    v_mfma_f32_16x16x32_bf16 v[36:39], v[52:55], v[120:123], v[36:39]
    v_mfma_f32_16x16x32_bf16 v[40:43], v[56:59], v[120:123], v[40:43]
    s_waitcnt vmcnt(0)
    s_barrier
    ds_read_b128 v[116:119], v16 offset:4096
    ds_read_b128 v[120:123], v17 offset:4096
    s_waitcnt lgkmcnt(4)
    v_mfma_f32_16x16x32_bf16 v[28:31], v[60:63], v[124:127], v[28:31]
    v_mfma_f32_16x16x32_bf16 v[32:35], v[64:67], v[124:127], v[32:35]
    v_mfma_f32_16x16x32_bf16 v[36:39], v[60:63], v[128:131], v[36:39]
    v_mfma_f32_16x16x32_bf16 v[40:43], v[64:67], v[128:131], v[40:43]
    ds_read_b128 v[124:127], v16 offset:5120
    ds_read_b128 v[128:131], v17 offset:5120
    s_waitcnt lgkmcnt(4)
    v_mfma_f32_16x16x32_bf16 v[28:31], v[68:71], v[108:111], v[28:31]
    v_mfma_f32_16x16x32_bf16 v[32:35], v[72:75], v[108:111], v[32:35]
    v_mfma_f32_16x16x32_bf16 v[36:39], v[68:71], v[112:115], v[36:39]
    v_mfma_f32_16x16x32_bf16 v[40:43], v[72:75], v[112:115], v[40:43]
    ds_read_b128 v[108:111], v16 offset:6144
    ds_read_b128 v[112:115], v17 offset:6144
    s_waitcnt lgkmcnt(4)
    v_mfma_f32_16x16x32_bf16 v[28:31], v[76:79], v[116:119], v[28:31]
    v_mfma_f32_16x16x32_bf16 v[32:35], v[80:83], v[116:119], v[32:35]
    v_mfma_f32_16x16x32_bf16 v[36:39], v[76:79], v[120:123], v[36:39]
    v_mfma_f32_16x16x32_bf16 v[40:43], v[80:83], v[120:123], v[40:43]
    ds_read_b128 v[116:119], v16 offset:7168
    ds_read_b128 v[120:123], v17 offset:7168
    s_waitcnt lgkmcnt(4)
    v_mfma_f32_16x16x32_bf16 v[28:31], v[84:87], v[124:127], v[28:31]
    v_mfma_f32_16x16x32_bf16 v[32:35], v[88:91], v[124:127], v[32:35]
    v_mfma_f32_16x16x32_bf16 v[36:39], v[84:87], v[128:131], v[36:39]
    v_mfma_f32_16x16x32_bf16 v[40:43], v[88:91], v[128:131], v[40:43]
    s_waitcnt lgkmcnt(2)
    v_mfma_f32_16x16x32_bf16 v[28:31], v[92:95], v[108:111], v[28:31]
    v_mfma_f32_16x16x32_bf16 v[32:35], v[96:99], v[108:111], v[32:35]
    v_mfma_f32_16x16x32_bf16 v[36:39], v[92:95], v[112:115], v[36:39]
    v_mfma_f32_16x16x32_bf16 v[40:43], v[96:99], v[112:115], v[40:43]
    s_waitcnt lgkmcnt(0)
    v_mfma_f32_16x16x32_bf16 v[28:31], v[100:103], v[116:119], v[28:31]
    v_mfma_f32_16x16x32_bf16 v[32:35], v[104:107], v[116:119], v[32:35]
    v_mfma_f32_16x16x32_bf16 v[36:39], v[100:103], v[120:123], v[36:39]
    v_mfma_f32_16x16x32_bf16 v[40:43], v[104:107], v[120:123], v[40:43]
    s_nop 6
    ds_write_b128 v21, v[36:39] offset:0
    ds_write_b128 v21, v[40:43] offset:1024
    s_waitcnt lgkmcnt(0)
    s_barrier
    ds_read_b128 v[44:47], v22 offset:0
    ds_read_b128 v[48:51], v22 offset:1024
    s_waitcnt lgkmcnt(0)
    v_add_f32 v28, v28, v44
    v_add_f32 v29, v29, v45
    v_add_f32 v30, v30, v46
    v_add_f32 v31, v31, v47
    v_add_f32 v32, v32, v48
    v_add_f32 v33, v33, v49
    v_add_f32 v34, v34, v50
    v_add_f32 v35, v35, v51
    v_cvt_pk_bf16_f32 v52, v28, v29
    v_lshlrev_b32 v28, 16, v52
    v_and_b32 v29, 0xffff0000, v52
    v_lshlrev_b32 v53, 16, v24
    v_and_b32 v54, 0xffff0000, v24
    v_add_f32 v28, v28, v53
    v_add_f32 v29, v29, v54
    v_cvt_pk_bf16_f32 v56, v28, v29
    v_cvt_pk_bf16_f32 v52, v30, v31
    v_lshlrev_b32 v30, 16, v52
    v_and_b32 v31, 0xffff0000, v52
    v_lshlrev_b32 v53, 16, v25
    v_and_b32 v54, 0xffff0000, v25
    v_add_f32 v30, v30, v53
    v_add_f32 v31, v31, v54
    v_cvt_pk_bf16_f32 v57, v30, v31
    v_cvt_pk_bf16_f32 v52, v32, v33
    v_lshlrev_b32 v32, 16, v52
    v_and_b32 v33, 0xffff0000, v52
    v_lshlrev_b32 v53, 16, v26
    v_and_b32 v54, 0xffff0000, v26
    v_add_f32 v32, v32, v53
    v_add_f32 v33, v33, v54
    v_cvt_pk_bf16_f32 v58, v32, v33
    v_cvt_pk_bf16_f32 v52, v34, v35
    v_lshlrev_b32 v34, 16, v52
    v_and_b32 v35, 0xffff0000, v52
    v_lshlrev_b32 v53, 16, v27
    v_and_b32 v54, 0xffff0000, v27
    v_add_f32 v34, v34, v53
    v_add_f32 v35, v35, v54
    v_cvt_pk_bf16_f32 v59, v34, v35
    buffer_store_dwordx4 v[56:59], v19, s[40:43], 0 offen
    s_nop 1
m_skipo1:
m_end:
    s_endpgm
.section .rodata,"a"
.p2align 6
.amdhsa_kernel interleave_layers__ssm_conv_h3__sliding_block__prompt_kernel
  .amdhsa_next_free_vgpr 256
  .amdhsa_next_free_sgpr 80
  .amdhsa_accum_offset 132
  .amdhsa_group_segment_fixed_size 0
  .amdhsa_kernarg_size 96
  .amdhsa_user_sgpr_count 2
  .amdhsa_user_sgpr_kernarg_segment_ptr 1
  .amdhsa_system_sgpr_workgroup_id_x 1
.end_amdhsa_kernel
```
